```python
import torch

def _softmax(x, axis=-1):
    return torch.softmax(x, dim=axis)

def _gelu(x):
    return torch.nn.functional.gelu(x, approximate='tanh')

def _silu(x):
    return torch.nn.functional.silu(x)

def _sigmoid(x):
    return torch.sigmoid(x)

def _layernorm(x, axis=-1, eps=1e-05):
    m = x.mean(dim=axis, keepdim=True)
    v = x.var(dim=axis, keepdim=True, unbiased=False)
    return (x - m) / torch.sqrt(v + eps)

def _scatter_add(tgt, idx, src, axis=0):
    return tgt.clone().index_add_(axis, idx, src)

def _segment_sum(src, seg, n):
    out = torch.zeros((n,) + src.shape[1:], dtype=src.dtype)
    return out.index_add_(0, seg, src)

def _pad(x, pw):
    flat = tuple((v for pair in reversed(pw) for v in pair))
    return torch.nn.functional.pad(x, flat)
kernel_name = 'concat_heads__grouped_kv_mqa__memory_aug_recurrent_mem_tr__prompt'

def setup_inputs():

    _w = lambda a: (lambda t: t.to(torch.bfloat16) if t.is_floating_point() else t)(torch.as_tensor(a))

    def _A_setup():
        B, S, D, H = (1, 2048, 1024, 32)
        Dh = D // H
        return {'x': _w((lambda *s: torch.randn(*s, dtype=torch.bfloat16) * 0.05)(B, S, D)), 'wq': _w((lambda *s: torch.randn(*s, dtype=torch.bfloat16) * 3.2)(D, H * Dh)), 'wk': _w((lambda *s: torch.randn(*s, dtype=torch.bfloat16) * 3.2)(D, Dh)), 'wv': _w((lambda *s: torch.randn(*s, dtype=torch.bfloat16) * 0.1)(D, Dh)), 'wo': _w((lambda *s: torch.randn(*s, dtype=torch.bfloat16) * 0.1)(H * Dh, D))}
    _A_in = _A_setup()

    def _B_setup():
        B, S, Dm = (1, 2048, 1024)
        H, Dh = (32, 128)
        M, seg = (8, 32)
        seg = min(seg, S)
        S = S // seg * seg
        return {'x': _w((lambda *s: torch.randn(*s, dtype=torch.bfloat16) * 0.05)(B, S, Dm)), 'mem0': _w((lambda *s: torch.randn(*s, dtype=torch.bfloat16) * 1.6)(B, M, Dm)), 'Wq': _w((lambda *s: torch.randn(*s, dtype=torch.bfloat16) * 0.8)(Dm, H, Dh) * Dm ** (-0.5)), 'Wk': _w((lambda *s: torch.randn(*s, dtype=torch.bfloat16) * 0.8)(Dm, H, Dh) * Dm ** (-0.5)), 'Wv': _w((lambda *s: torch.randn(*s, dtype=torch.bfloat16) * 1.6)(Dm, H, Dh) * Dm ** (-0.5)), 'Wo': _w((lambda *s: torch.randn(*s, dtype=torch.bfloat16) * 1.6)(H, Dh, Dm) * (H * Dh) ** (-0.5)), 'seg_len': seg}
    _B_in = _B_setup()
    return {'A_x': _A_in['x'], 'A_wq': _A_in['wq'], 'A_wk': _A_in['wk'], 'A_wv': _A_in['wv'], 'A_wo': _A_in['wo'], 'B_x': _B_in['x'], 'B_mem0': _B_in['mem0'], 'B_Wq': _B_in['Wq'], 'B_Wk': _B_in['Wk'], 'B_Wv': _B_in['Wv'], 'B_Wo': _B_in['Wo'], 'B_seg_len': _B_in['seg_len']}

def reference(A_x, A_wq, A_wk, A_wv, A_wo, B_x, B_mem0, B_Wq, B_Wk, B_Wv, B_Wo, B_seg_len):

    def _A_ref(x, wq, wk, wv, wo):
        B, S, D = x.shape
        H = 32
        Dh = D // H
        q = (lambda x, *d: x.permute(*d))((x @ wq).reshape(B, S, H, Dh), 0, 2, 1, 3)
        k = x @ wk
        v = x @ wv
        scores = torch.einsum('bhqd,bkd->bhqk', q, k) * Dh ** (-0.5)
        p = _softmax(scores, axis=-1)
        o = torch.einsum('bhqk,bkd->bhqd', p, v)
        return (lambda x, *d: x.permute(*d))(o, 0, 2, 1, 3).reshape(B, S, H * Dh) @ wo

    def _B_ref(x, mem0, Wq, Wk, Wv, Wo, seg_len):
        B, S, Dm = x.shape
        H, Dh = (Wq.shape[1], Wq.shape[2])
        M = mem0.shape[1]
        scale = Dh ** (-0.5)
        n_seg = S // seg_len
        L = M + seg_len
        idx = torch.arange(L)
        mask = (idx[:, None] < M) | (idx[:, None] >= idx[None, :])
        mem = mem0
        outs = []
        for s in range(n_seg):
            xs = x[:, s * seg_len:(s + 1) * seg_len, :].clone()
            h = torch.concatenate([mem, xs], axis=1)
            q = torch.einsum('btd,dhe->bhte', h, Wq)
            k = torch.einsum('btd,dhe->bhte', h, Wk)
            v = torch.einsum('btd,dhe->bhte', h, Wv)
            scores = torch.einsum('bhqe,bhke->bhqk', q, k) * scale
            scores = torch.where(mask[None, None], scores, -1000000000.0)
            p = _softmax(scores, axis=-1)
            o = torch.einsum('bhqk,bhke->bhqe', p, v)
            o = torch.einsum('bhte,hed->btd', o, Wo)
            mem = o[:, :M, :].clone()
            outs.append(o[:, M:, :])
        return torch.concatenate(outs, axis=1)
    a = _A_ref(A_x, A_wq, A_wk, A_wv, A_wo)
    b = _B_ref(B_x, B_mem0, B_Wq, B_Wk, B_Wv, B_Wo, B_seg_len)
    return torch.concatenate([a, b], axis=-1)
```

```asm
; @launch grid=(256,1,1) block=(512,1,1) lds=163840
.amdgcn_target "amdgcn-amd-amdhsa--gfx950"
.text
.globl concat_heads__grouped_kv_mqa__memory_aug_recurrent_mem_tr__prompt_kernel
.p2align 8
.type concat_heads__grouped_kv_mqa__memory_aug_recurrent_mem_tr__prompt_kernel,@function
concat_heads__grouped_kv_mqa__memory_aug_recurrent_mem_tr__prompt_kernel:
s_cmp_ge_u32 s2, 256
s_cbranch_scc1 Lend
s_load_dwordx16 s[4:19], s[0:1], 0
s_load_dwordx8 s[20:27], s[0:1], 64
s_load_dwordx4 s[28:31], s[0:1], 96
s_load_dwordx2 s[32:33], s[0:1], 112
s_getpc_b64 s[48:49]
Lpc:
v_lshlrev_b32 v2, 7, v0
v_min_u32 v2, Lend-Lpc, v2
global_load_dword v91, v2, s[48:49]
s_and_b32 s50, s2, 3
s_lshl_b32 s50, s50, 5
s_lshr_b32 s51, s2, 3
s_add_u32 s70, s50, s51
s_lshl_b32 s50, s70, 6
s_add_u32 s50, s50, Ltab-Lpc
v_and_b32 v2, 15, v0
v_lshl_add_u32 v2, v2, 2, s50
global_load_dword v90, v2, s[48:49]
v_lshrrev_b32 v1, 6, v0
s_mov_b32 s35, s2
v_readfirstlane_b32 s34, v1
v_and_b32 v0, 63, v0
s_waitcnt lgkmcnt(0)
s_and_b32 s48, s2, 3
s_lshl_b32 s48, s48, 1
s_lshr_b32 s49, s2, 7
s_add_u32 s48, s48, s49
s_bfe_u32 s49, s2, 0x40003
s_lshl_b32 s49, s49, 3
s_add_u32 s35, s48, s49
s_bitcmp1_b32 s2, 2
s_cbranch_scc1 Lworker
s_and_b32 s56, s35, 7
s_lshr_b32 s57, s35, 3
s_and_b32 s58, s34, 3
s_mov_b32 s64, 0
s_mov_b32 s65, 0
s_mov_b32 s62, 0x05040100
s_mov_b32 s63, 0x07060100
s_mov_b32 s59, 0x3e0293ee
s_add_u32 s68, s32, 80740352
s_addc_u32 s69, s33, 0
s_add_u32 s70, s68, 20480
s_addc_u32 s71, s69, 0
s_mul_i32 s48, s56, 24576
s_add_u32 s48, s48, 82837504
s_add_u32 s72, s32, s48
s_addc_u32 s73, s33, 0
s_add_u32 s74, s72, 262144
s_addc_u32 s75, s73, 0
s_add_u32 s76, s32, 16777216
s_addc_u32 s77, s33, 0
s_add_u32 s78, s32, 33554432
s_addc_u32 s79, s33, 0
s_add_u32 s60, s32, 99614720
s_addc_u32 s61, s33, 0
v_mov_b32 v11, -1
v_and_b32 v12, 3, v0
v_bfe_u32 v13, v0, 2, 3
v_lshrrev_b32 v14, 5, v0
v_mov_b32 v2, 0x4444
v_mov_b32 v15, 0xeeee
v_and_b32 v16, 8, v0
v_cmp_ne_u32 vcc, 0, v16
s_nop 1
v_cndmask_b32 v2, v2, v15, vcc
s_lshl_b32 s48, s34, 4
v_lshlrev_b32 v15, 2, v12
v_lshlrev_b32 v16, 1, v14
v_add3_u32 v15, v15, v16, s48
v_add_u32 v16, 1, v15
v_lshlrev_b32 v17, 5, v12
v_bfe_u32 v22, v0, 3, 1
v_lshl_add_u32 v17, v22, 1, v17
v_add_u32 v17, 13, v17
v_add_u32 v18, 16, v17
s_cmp_eq_u32 s34, 4
s_cselect_b64 s[48:49], -1, 0
v_cndmask_b32 v15, v15, v17, s[48:49]
v_cndmask_b32 v16, v16, v18, s[48:49]
v_cmp_le_u32 s[50:51], 2, v12
s_nop 0
s_and_b64 s[50:51], s[50:51], s[48:49]
v_cmp_eq_u32 s[52:53], 2, v12
s_nop 0
s_and_b64 s[52:53], s[52:53], s[48:49]
v_cmp_eq_u32 s[54:55], 3, v12
v_mov_b32 v21, v13
v_and_b32 v17, 4, v0
v_or_b32 v17, 3, v17
v_cndmask_b32 v21, v13, v17, s[48:49]
s_or_b32 s48, s48, 0x80008000
s_or_b32 s49, s49, 0x80008000
s_and_b64 s[54:55], s[54:55], s[48:49]
v_lshrrev_b32 v17, 2, v15
v_mul_u32_u24 v17, 160, v17
v_and_b32 v18, 3, v15
v_lshlrev_b32 v18, 5, v18
v_add_u32 v17, v17, v18
v_lshl_add_u32 v17, v21, 2, v17
v_add_u32 v7, 18432, v17
v_lshrrev_b32 v17, 2, v16
v_mul_u32_u24 v17, 160, v17
v_and_b32 v18, 3, v16
v_lshlrev_b32 v18, 5, v18
v_add_u32 v17, v17, v18
v_lshl_add_u32 v17, v21, 2, v17
v_add_u32 v8, 18432, v17
v_mov_b32 v17, 18564
v_mov_b32 v18, 18564
v_cndmask_b32 v7, v7, v18, s[50:51]
v_cndmask_b32 v8, v8, v18, s[52:53]
v_cndmask_b32 v8, v8, v17, s[54:55]
s_mul_i32 s67, s57, 5
s_add_u32 s67, s67, s34
s_mul_i32 s67, s67, 256
v_lshlrev_b32 v9, 2, v0
v_add_u32 v9, s67, v9
s_cmp_lg_u32 s56, 0
s_cbranch_scc1 Lnomem0_2
s_cmp_gt_u32 s34, 4
s_cbranch_scc1 Lnomem0_2
s_lshl_b32 s48, s57, 7
v_lshlrev_b32 v17, 11, v21
v_add_u32 v17, s48, v17
v_and_b32 v15, 63, v15
v_and_b32 v16, 63, v16
v_lshl_add_u32 v15, v15, 1, v17
v_lshl_add_u32 v16, v16, 1, v17
global_load_ushort v24, v15, s[16:17]
global_load_ushort v25, v16, s[16:17]
v_cndmask_b32 v26, -1, 0, s[50:51]
s_or_b64 s[52:53], s[52:53], s[54:55]
v_cndmask_b32 v27, -1, 0, s[52:53]
v_mov_b32 v17, 0x41000000
v_cndmask_b32 v28, 0, v17, s[54:55]
Lnomem0_2:
s_mul_i32 s48, s35, 640
s_lshl_b32 s49, s34, 6
s_add_u32 s48, s48, s49
v_mov_b64 v[16:17], 0
v_mov_b64 v[18:19], 0
v_add_u32 v15, s48, v0
v_lshlrev_b32 v15, 4, v15
global_store_dwordx4 v15, v[16:19], s[70:71] sc1
s_cmp_gt_u32 s34, 1
s_cbranch_scc1 Lz_3
s_add_u32 s48, s48, 512
v_add_u32 v15, s48, v0
v_lshlrev_b32 v15, 4, v15
global_store_dwordx4 v15, v[16:19], s[70:71] sc1
Lz_3:
s_lshr_b32 s48, s57, 2
s_mul_i32 s48, s48, 6144
s_and_b32 s49, s57, 3
s_cmp_ge_u32 s34, 4
s_cbranch_scc1 LS2i_4
s_and_b32 s50, s34, 1
s_lshl_b32 s51, s50, 3
v_lshl_add_u32 v15, v12, 1, v14
v_add_u32 v15, s51, v15
v_mul_u32_u24 v15, 96, v15
v_lshl_add_u32 v15, v13, 2, v15
v_add_u32 v4, 3072, v15
v_add_u32 v5, 32, v4
s_lshl_b32 s49, s49, 9
s_lshl_b32 s50, s50, 8
s_add_u32 s48, s48, s49
s_add_u32 s48, s48, s50
s_add_u32 s48, s48, 4096
s_branch Lji_5
LS2i_4:
s_lshl_b32 s51, s58, 2
v_add_u32 v15, s51, v12
v_mul_u32_u24 v15, 96, v15
v_lshl_add_u32 v15, v13, 2, v15
v_xor_b32 v16, 1, v14
v_mul_u32_u24 v16, 1536, v16
v_add3_u32 v4, v15, v16, 0
v_add_u32 v5, 32, v4
s_lshl_b32 s49, s49, 10
s_lshl_b32 s50, s58, 8
s_add_u32 s48, s48, s49
s_add_u32 s48, s48, s50
Lji_5:
v_lshlrev_b32 v6, 2, v0
v_add_u32 v6, s48, v6
global_store_dword v6, v11, s[72:73] sc1
global_store_dword v6, v11, s[74:75] sc1
s_min_u32 s48, s34, 2
s_mul_i32 s49, s35, 3
s_add_u32 s48, s48, s49
s_lshl_b32 s48, s48, 8
s_add_u32 s48, s48, 83361792
v_lshl_add_u32 v15, v0, 2, s48
global_store_dword v15, v11, s[32:33] sc1
s_cmp_ge_u32 s34, 4
s_cbranch_scc1 LS2_6
s_lshl_b32 s48, s56, 2
s_lshr_b32 s49, s57, 2
s_add_u32 s48, s48, s49
s_lshl_b32 s48, s48, 8
s_and_b32 s49, s57, 3
s_lshl_b32 s49, s49, 6
s_add_u32 s48, s48, s49
s_lshl_b32 s49, s58, 19
s_add_u32 s52, s48, s49
v_lshrrev_b32 v12, 2, v0
v_lshlrev_b32 v12, 13, v12
v_and_b32 v13, 3, v0
v_lshl_add_u32 v12, v13, 4, v12
s_lshl_b32 s53, s58, 15
v_lshrrev_b32 v13, 5, v0
v_lshlrev_b32 v13, 6, v13
v_bfe_u32 v14, v0, 4, 1
v_lshl_add_u32 v13, v14, 3, v13
v_bfe_u32 v14, v0, 2, 2
v_add_u32 v13, v13, v14
v_lshlrev_b32 v13, 6, v13
v_and_b32 v14, 3, v0
v_lshl_add_u32 v13, v14, 3, v13
v_add_u32 v13, s53, v13
s_mov_b32 s40, s18
s_mov_b32 s41, s19
s_mov_b32 s42, 8388608
s_add_u32 s40, s40, s52
s_addc_u32 s41, s41, 0
s_sub_u32 s42, s42, s52
s_and_b32 s41, s41, 0xffff
s_mov_b32 s43, 0x20000
s_mov_b32 s44, s20
s_mov_b32 s45, s21
s_mov_b32 s46, 8388608
s_add_u32 s44, s44, s52
s_addc_u32 s45, s45, 0
s_sub_u32 s46, s46, s52
s_and_b32 s45, s45, 0xffff
s_mov_b32 s47, 0x20000
s_mov_b32 m0, s53
s_mov_b32 s54, 0
Lw1_7:
buffer_load_dwordx4 v12, s[40:43], s54 offen lds
s_add_u32 m0, m0, 16384
s_nop 0
buffer_load_dwordx4 v12, s[44:47], s54 offen lds
s_add_u32 m0, m0, 0xffffc400
s_add_u32 s54, s54, 131072
s_bitcmp1_b32 s54, 19
s_cselect_b32 s55, 1572864, 0
s_add_u32 s54, s54, s55
s_cmp_lt_u32 s54, 4194304
s_cbranch_scc1 Lw1_7
s_waitcnt vmcnt(16)
s_cmp_lg_u32 s56, 0
s_cbranch_scc1 Lm0_8_n
s_cmp_gt_u32 s34, 4
s_cbranch_scc1 Lm0_8_n
v_and_b32 v24, v24, v26
v_and_b32 v25, v25, v27
v_lshl_or_b32 v24, v25, 16, v24
v_or_b32 v24, v24, v28
global_store_dword v9, v24, s[68:69] sc1
Lm0_8_n:
Lw1_9:
buffer_load_dwordx4 v12, s[40:43], s54 offen lds
s_add_u32 m0, m0, 16384
s_nop 0
buffer_load_dwordx4 v12, s[44:47], s54 offen lds
s_add_u32 m0, m0, 0xffffc400
s_add_u32 s54, s54, 131072
s_bitcmp1_b32 s54, 19
s_cselect_b32 s55, 1572864, 0
s_add_u32 s54, s54, s55
s_cmp_lt_u32 s54, 8388608
s_cbranch_scc1 Lw1_9
s_waitcnt vmcnt(16)
s_barrier
s_cmp_lg_u32 s34, 7
s_cbranch_scc1 La_10
s_getreg_b32 s48, hwreg(HW_REG_XCC_ID)
s_and_b32 s48, s48, 15
s_mul_i32 s49, s48, s48
s_lshl_b32 s49, s49, 8
s_add_u32 s48, s48, s49
s_lshl_b32 s48, s48, 8
s_add_u32 s48, s48, 1
s_lshl_b32 s49, s56, 2
s_mov_b64 exec, 1
v_mov_b32 v15, s49
v_mov_b32 v16, s48
global_atomic_add v15, v16, s[30:31] offset:4
s_mov_b64 exec, -1
La_10:
s_mov_b32 s40, s22
s_mov_b32 s41, s23
s_mov_b32 s42, 8388608
s_add_u32 s40, s40, s52
s_addc_u32 s41, s41, 0
s_sub_u32 s42, s42, s52
s_and_b32 s41, s41, 0xffff
s_mov_b32 s43, 0x20000
s_waitcnt vmcnt(0)
ds_read_b64_tr_b16 v[64:65], v13 offset:0
ds_read_b64_tr_b16 v[66:67], v13 offset:256
ds_read_b64_tr_b16 v[68:69], v13 offset:8192
ds_read_b64_tr_b16 v[70:71], v13 offset:8448
ds_read_b64_tr_b16 v[72:73], v13 offset:1024
ds_read_b64_tr_b16 v[74:75], v13 offset:1280
ds_read_b64_tr_b16 v[76:77], v13 offset:9216
ds_read_b64_tr_b16 v[78:79], v13 offset:9472
ds_read_b64_tr_b16 v[80:81], v13 offset:2048
ds_read_b64_tr_b16 v[82:83], v13 offset:2304
ds_read_b64_tr_b16 v[84:85], v13 offset:10240
ds_read_b64_tr_b16 v[86:87], v13 offset:10496
ds_read_b64_tr_b16 v[88:89], v13 offset:3072
ds_read_b64_tr_b16 v[90:91], v13 offset:3328
ds_read_b64_tr_b16 v[92:93], v13 offset:11264
ds_read_b64_tr_b16 v[94:95], v13 offset:11520
ds_read_b64_tr_b16 v[96:97], v13 offset:32
ds_read_b64_tr_b16 v[98:99], v13 offset:288
ds_read_b64_tr_b16 v[100:101], v13 offset:8224
ds_read_b64_tr_b16 v[102:103], v13 offset:8480
ds_read_b64_tr_b16 v[104:105], v13 offset:1056
ds_read_b64_tr_b16 v[106:107], v13 offset:1312
ds_read_b64_tr_b16 v[108:109], v13 offset:9248
ds_read_b64_tr_b16 v[110:111], v13 offset:9504
ds_read_b64_tr_b16 v[112:113], v13 offset:2080
ds_read_b64_tr_b16 v[114:115], v13 offset:2336
ds_read_b64_tr_b16 v[116:117], v13 offset:10272
ds_read_b64_tr_b16 v[118:119], v13 offset:10528
ds_read_b64_tr_b16 v[120:121], v13 offset:3104
ds_read_b64_tr_b16 v[122:123], v13 offset:3360
ds_read_b64_tr_b16 v[124:125], v13 offset:11296
ds_read_b64_tr_b16 v[126:127], v13 offset:11552
s_waitcnt lgkmcnt(0)
s_mov_b32 m0, s53
s_mov_b32 s54, 0
Lw1_11:
buffer_load_dwordx4 v12, s[40:43], s54 offen lds
s_add_u32 m0, m0, 0x400
s_add_u32 s54, s54, 131072
s_bitcmp1_b32 s54, 19
s_cselect_b32 s55, 1572864, 0
s_add_u32 s54, s54, s55
s_cmp_lt_u32 s54, 8388608
s_cbranch_scc1 Lw1_11
ds_read_b64_tr_b16 v[128:129], v13 offset:16384
ds_read_b64_tr_b16 v[130:131], v13 offset:16640
ds_read_b64_tr_b16 v[132:133], v13 offset:24576
ds_read_b64_tr_b16 v[134:135], v13 offset:24832
ds_read_b64_tr_b16 v[136:137], v13 offset:17408
ds_read_b64_tr_b16 v[138:139], v13 offset:17664
ds_read_b64_tr_b16 v[140:141], v13 offset:25600
ds_read_b64_tr_b16 v[142:143], v13 offset:25856
ds_read_b64_tr_b16 v[144:145], v13 offset:18432
ds_read_b64_tr_b16 v[146:147], v13 offset:18688
ds_read_b64_tr_b16 v[148:149], v13 offset:26624
ds_read_b64_tr_b16 v[150:151], v13 offset:26880
ds_read_b64_tr_b16 v[152:153], v13 offset:19456
ds_read_b64_tr_b16 v[154:155], v13 offset:19712
ds_read_b64_tr_b16 v[156:157], v13 offset:27648
ds_read_b64_tr_b16 v[158:159], v13 offset:27904
ds_read_b64_tr_b16 v[160:161], v13 offset:16416
ds_read_b64_tr_b16 v[162:163], v13 offset:16672
ds_read_b64_tr_b16 v[164:165], v13 offset:24608
ds_read_b64_tr_b16 v[166:167], v13 offset:24864
ds_read_b64_tr_b16 v[168:169], v13 offset:17440
ds_read_b64_tr_b16 v[170:171], v13 offset:17696
ds_read_b64_tr_b16 v[172:173], v13 offset:25632
ds_read_b64_tr_b16 v[174:175], v13 offset:25888
ds_read_b64_tr_b16 v[176:177], v13 offset:18464
ds_read_b64_tr_b16 v[178:179], v13 offset:18720
ds_read_b64_tr_b16 v[180:181], v13 offset:26656
ds_read_b64_tr_b16 v[182:183], v13 offset:26912
ds_read_b64_tr_b16 v[184:185], v13 offset:19488
ds_read_b64_tr_b16 v[186:187], v13 offset:19744
ds_read_b64_tr_b16 v[188:189], v13 offset:27680
ds_read_b64_tr_b16 v[190:191], v13 offset:27936
s_waitcnt vmcnt(0)
ds_read_b64_tr_b16 v[192:193], v13 offset:0
ds_read_b64_tr_b16 v[194:195], v13 offset:256
ds_read_b64_tr_b16 v[196:197], v13 offset:8192
ds_read_b64_tr_b16 v[198:199], v13 offset:8448
ds_read_b64_tr_b16 v[200:201], v13 offset:1024
ds_read_b64_tr_b16 v[202:203], v13 offset:1280
ds_read_b64_tr_b16 v[204:205], v13 offset:9216
ds_read_b64_tr_b16 v[206:207], v13 offset:9472
ds_read_b64_tr_b16 v[208:209], v13 offset:2048
ds_read_b64_tr_b16 v[210:211], v13 offset:2304
ds_read_b64_tr_b16 v[212:213], v13 offset:10240
ds_read_b64_tr_b16 v[214:215], v13 offset:10496
ds_read_b64_tr_b16 v[216:217], v13 offset:3072
ds_read_b64_tr_b16 v[218:219], v13 offset:3328
ds_read_b64_tr_b16 v[220:221], v13 offset:11264
ds_read_b64_tr_b16 v[222:223], v13 offset:11520
ds_read_b64_tr_b16 v[224:225], v13 offset:32
ds_read_b64_tr_b16 v[226:227], v13 offset:288
ds_read_b64_tr_b16 v[228:229], v13 offset:8224
ds_read_b64_tr_b16 v[230:231], v13 offset:8480
ds_read_b64_tr_b16 v[232:233], v13 offset:1056
ds_read_b64_tr_b16 v[234:235], v13 offset:1312
ds_read_b64_tr_b16 v[236:237], v13 offset:9248
ds_read_b64_tr_b16 v[238:239], v13 offset:9504
ds_read_b64_tr_b16 v[240:241], v13 offset:2080
ds_read_b64_tr_b16 v[242:243], v13 offset:2336
ds_read_b64_tr_b16 v[244:245], v13 offset:10272
ds_read_b64_tr_b16 v[246:247], v13 offset:10528
ds_read_b64_tr_b16 v[248:249], v13 offset:3104
ds_read_b64_tr_b16 v[250:251], v13 offset:3360
ds_read_b64_tr_b16 v[252:253], v13 offset:11296
ds_read_b64_tr_b16 v[254:255], v13 offset:11552
v_lshrrev_b32 v1, 4, v0
v_lshl_add_u32 v1, v1, 2, s58
v_mul_u32_u24 v1, 1280, v1
v_and_b32 v14, 15, v0
v_lshl_add_u32 v1, v14, 4, v1
v_lshrrev_b32 v15, 5, v0
v_lshl_add_u32 v14, v15, 4, v14
v_lshrrev_b32 v15, 1, v14
v_mul_u32_u24 v15, 96, v15
v_and_b32 v14, 1, v14
v_lshl_add_u32 v15, v14, 5, v15
v_bfe_u32 v14, v0, 4, 1
v_lshl_add_u32 v15, v14, 4, v15
s_mul_i32 s48, s58, 4608
s_add_u32 s48, s48, 0
v_add_u32 v3, s48, v15
s_waitcnt lgkmcnt(0)
s_mov_b32 s36, s32
s_mov_b32 s37, s33
s_mov_b32 s38, 268435456
s_and_b32 s37, s37, 0xffff
s_mov_b32 s39, 0x20000
s_and_b32 s48, s34, 1
s_mul_i32 s47, s48, 1536
s_add_u32 s54, s47, 98304
s_mul_i32 s53, s58, 3072
s_sub_u32 s52, s53, s47
s_add_u32 s53, s53, 98304
s_mul_i32 s49, s56, 12288
s_add_u32 s47, s47, s49
s_add_u32 s47, s47, 83361792
s_lshl_b32 s48, s48, 11
s_lshl_b32 s43, s35, 12
s_add_u32 s43, s43, s48
s_lshr_b32 s48, s34, 1
s_mul_i32 s42, s48, 3072
s_add_u32 s42, s42, 32768
s_lshl_b32 s48, s48, 10
s_add_u32 s43, s43, s48
v_lshlrev_b32 v14, 4, v0
s_and_b32 s48, s57, 3
s_mul_i32 s48, s48, 98304
s_lshr_b32 s49, s57, 2
s_min_u32 s49, s49, 2
s_lshl_b32 s49, s49, 10
s_add_u32 s48, s48, s49
s_add_u32 s55, s47, s52
s_add_u32 s55, s55, s48
buffer_load_dwordx4 v[20:23], v14, s[36:39], s55 offen sc1
v_and_b32 v12, 7, v0
v_lshlrev_b32 v12, 2, v12
Lws_12:
s_sleep 4
global_load_dword v14, v12, s[30:31] offset:4 sc1
s_add_u32 s65, s65, 1
s_cmp_gt_u32 s65, 400000
s_cbranch_scc1 Lcfail_1
s_waitcnt vmcnt(0)
Lws_12_c:
v_and_b32 v13, 255, v14
v_cmp_gt_u32 vcc, 16, v13
s_cbranch_vccnz Lws_12
v_readlane_b32 s48, v14, s56
s_nop 0
s_bfe_u32 s49, s48, 0x80008
s_mul_i32 s49, s49, s49
s_lshr_b32 s48, s48, 16
s_lshl_b32 s48, s48, 4
s_sub_u32 s66, s48, s49
s_barrier
s_barrier
s_setprio 3
s_mov_b32 s67, 0x41000000
v_lshl_add_u32 v15, v0, 4, s43
v_and_b32 v14, 15, v0
v_mul_u32_u24 v14, 12, v14
v_sub_u32 v14, v1, v14
.p2align 6
s_nop 0
s_nop 0
s_nop 0
s_nop 0
L1_13:
LpA_14:
global_load_dword v39, v14, s[68:69] offset:1024 sc1
global_load_dwordx4 v[20:23], v1, s[68:69] offset:0 sc1
global_load_dwordx4 v[24:27], v1, s[68:69] offset:256 sc1
global_load_dwordx4 v[28:31], v1, s[68:69] offset:512 sc1
global_load_dwordx4 v[32:35], v1, s[68:69] offset:768 sc1
LpA_14_j:
s_lshl_b32 s48, s58, 2
v_mov_b32 v12, s48
v_mov_b32 v13, s64
ds_write_b32 v12, v13 offset:29248
s_add_u32 s65, s65, 1
s_cmp_gt_u32 s65, 400000
s_cbranch_scc1 Lcfail_1
v_mov_b64 v[40:41], 0
v_mov_b64 v[42:43], 0
v_mov_b64 v[44:45], 0
v_mov_b64 v[46:47], 0
v_mov_b64 v[48:49], 0
v_mov_b64 v[50:51], 0
v_mov_b64 v[52:53], 0
v_mov_b64 v[54:55], 0
v_mov_b64 v[56:57], 0
v_mov_b64 v[58:59], 0
v_mov_b64 v[60:61], 0
v_mov_b64 v[62:63], 0
s_waitcnt vmcnt(4)
v_mov_b32_dpp v36, v39 quad_perm:[0,0,0,0] row_mask:0xf bank_mask:0xf
v_mov_b32_dpp v37, v39 quad_perm:[1,1,1,1] row_mask:0xf bank_mask:0xf
s_mov_b32 exec_lo, 0x88888888
s_mov_b32 exec_hi, 0x88888888
s_waitcnt vmcnt(3)
v_min_u32 v10, v23, v39
v_perm_b32 v23, v36, v23, s62
s_nop 1
v_smfmac_f32_16x16x64_bf16 v[40:43], v[20:23], v[64:71], v2
v_smfmac_f32_16x16x64_bf16 v[44:47], v[20:23], v[96:103], v2
v_smfmac_f32_16x16x64_bf16 v[48:51], v[20:23], v[128:135], v2
v_smfmac_f32_16x16x64_bf16 v[52:55], v[20:23], v[160:167], v2
v_smfmac_f32_16x16x64_bf16 v[56:59], v[20:23], v[192:199], v2
s_waitcnt vmcnt(2)
v_min_u32 v10, v27, v10
v_perm_b32 v27, v36, v27, s63
v_smfmac_f32_16x16x64_bf16 v[60:63], v[20:23], v[224:231], v2
s_nop 0
v_smfmac_f32_16x16x64_bf16 v[40:43], v[24:27], v[72:79], v2
v_smfmac_f32_16x16x64_bf16 v[44:47], v[24:27], v[104:111], v2
v_smfmac_f32_16x16x64_bf16 v[48:51], v[24:27], v[136:143], v2
s_waitcnt vmcnt(1)
v_min_u32 v10, v31, v10
v_perm_b32 v31, v37, v31, s62
v_smfmac_f32_16x16x64_bf16 v[52:55], v[24:27], v[168:175], v2
s_nop 0
v_smfmac_f32_16x16x64_bf16 v[40:43], v[28:31], v[80:87], v2
s_waitcnt vmcnt(0)
v_min_u32 v10, v35, v10
v_perm_b32 v35, v37, v35, s63
v_smfmac_f32_16x16x64_bf16 v[44:47], v[28:31], v[112:119], v2
v_cmp_gt_u32 vcc, s67, v10
v_smfmac_f32_16x16x64_bf16 v[40:43], v[32:35], v[88:95], v2
s_mov_b64 exec, -1
s_cbranch_vccnz LpA_14_retry
v_smfmac_f32_16x16x64_bf16 v[44:47], v[32:35], v[120:127], v2
v_smfmac_f32_16x16x64_bf16 v[48:51], v[28:31], v[144:151], v2
s_nop 0
v_smfmac_f32_16x16x64_bf16 v[52:55], v[28:31], v[176:183], v2
s_nop 0
v_smfmac_f32_16x16x64_bf16 v[48:51], v[32:35], v[152:159], v2
s_nop 0
v_smfmac_f32_16x16x64_bf16 v[52:55], v[32:35], v[184:191], v2
s_nop 0
v_smfmac_f32_16x16x64_bf16 v[56:59], v[24:27], v[200:207], v2
v_permlane32_swap_b32 v40, v44
v_permlane32_swap_b32 v41, v45
v_smfmac_f32_16x16x64_bf16 v[60:63], v[24:27], v[232:239], v2
v_permlane32_swap_b32 v42, v46
v_permlane32_swap_b32 v43, v47
v_smfmac_f32_16x16x64_bf16 v[56:59], v[28:31], v[208:215], v2
v_add_f32 v40, v40, v44
v_add_f32 v41, v41, v45
v_smfmac_f32_16x16x64_bf16 v[60:63], v[28:31], v[240:247], v2
v_add_f32 v42, v42, v46
v_add_f32 v43, v43, v47
v_smfmac_f32_16x16x64_bf16 v[56:59], v[32:35], v[216:223], v2
ds_write_b128 v3, v[40:43] offset:0
v_permlane32_swap_b32 v48, v52
v_smfmac_f32_16x16x64_bf16 v[60:63], v[32:35], v[248:255], v2
v_permlane32_swap_b32 v49, v53
v_permlane32_swap_b32 v50, v54
v_permlane32_swap_b32 v51, v55
v_add_f32 v48, v48, v52
v_add_f32 v49, v49, v53
v_add_f32 v50, v50, v54
v_add_f32 v51, v51, v55
ds_write_b128 v3, v[48:51] offset:1536
v_permlane32_swap_b32 v56, v60
v_permlane32_swap_b32 v57, v61
v_permlane32_swap_b32 v58, v62
v_permlane32_swap_b32 v59, v63
v_add_f32 v56, v56, v60
v_add_f32 v57, v57, v61
v_add_f32 v58, v58, v62
v_add_f32 v59, v59, v63
ds_write_b128 v3, v[56:59] offset:3072
s_setprio 1
s_waitcnt lgkmcnt(0)
s_barrier
s_cmp_gt_u32 s34, 1
s_cbranch_scc1 Lnp_16_o
ds_read2st64_b32 v[24:25], v4 offset0:0 offset1:18
ds_read2st64_b32 v[26:27], v5 offset0:0 offset1:18
ds_read2st64_b32 v[28:29], v4 offset0:36 offset1:54
ds_read2st64_b32 v[30:31], v5 offset0:36 offset1:54
s_cmp_lg_u32 s66, 0
s_waitcnt lgkmcnt(2)
v_add_f32 v24, v24, v25
v_add_f32 v26, v26, v27
s_waitcnt lgkmcnt(0)
v_add_f32 v28, v28, v29
v_add_f32 v30, v30, v31
v_add_f32 v24, v24, v28
v_add_f32 v26, v26, v30
v_cvt_pk_bf16_f32 v24, v24, v26
v_min_u32 v24, -2, v24
s_cbranch_scc1 Lslow_17
global_store_dword v6, v24, s[72:73]
global_store_dword v6, v11, s[74:75]
Lback_18:
s_waitcnt vmcnt(0)
Lnp_16:
.p2align 5
Lnp_16_e:
s_xor_b32 s42, s42, 98304
s_add_u32 s44, s64, 3
s_and_b32 s44, s44, 3
s_mul_i32 s44, s44, 98304
s_add_u32 s44, s44, s47
s_add_u32 s45, s44, 6144
s_add_u32 s40, s44, 1024
s_add_u32 s41, s45, 1024
v_lshl_add_u32 v20, v0, 4, s42
v_add_u32 v21, 8, v20
v_bfe_u32 v23, v0, 2, 3
v_lshlrev_b32 v23, 4, v23
v_add_u32 v23, 28800, v23
v_and_b32 v24, 15, v0
v_cmp_eq_u32 vcc, 15, v24
s_nop 1
v_cndmask_b32 v24, 0, 1.0, vcc
s_cmp_eq_u32 s64, 64
s_cbranch_scc1 Lnp_16_f
s_add_u32 s55, s44, s52
s_mov_b32 m0, s53
v_lshlrev_b32 v14, 4, v0
v_lshl_add_u32 v22, v0, 4, s54
v_lshl_add_u32 v25, v0, 3, s54
s_lshl_b32 s48, s58, 2
s_add_u32 s49, s64, 1
v_mov_b32 v26, s48
v_mov_b32 v27, s49
v_and_b32 v12, 7, v0
v_lshlrev_b32 v12, 2, v12
s_sleep 3
buffer_load_dwordx4 v14, s[36:39], s55 offen offset:0 sc1 lds
buffer_load_dwordx4 v14, s[36:39], s55 offen offset:1024 sc1 lds
buffer_load_dwordx4 v14, s[36:39], s55 offen offset:2048 sc1 lds
s_waitcnt vmcnt(0)
ds_write_b32 v26, v27 offset:29184
Lnp_16_w:
s_sleep 2
ds_read_b32 v13, v12 offset:29168
s_add_u32 s65, s65, 1
s_cmp_gt_u32 s65, 400000
s_cbranch_scc1 Lcfail_1
s_waitcnt lgkmcnt(0)
v_cmp_ge_u32 vcc, s64, v13
s_cbranch_vccnz Lnp_16_w
global_store_dwordx4 v15, v[16:19], s[60:61] sc1
ds_read_b128 v[40:43], v22 offset:0
ds_read_b128 v[44:47], v22 offset:3072
ds_read_b128 v[48:51], v22 offset:6144
ds_read_b128 v[52:55], v22 offset:9216
ds_read2st64_b64 v[56:59], v25 offset0:2 offset1:8
ds_read2st64_b64 v[60:63], v25 offset0:14 offset1:20
Lnp_16_g:
s_add_u32 s60, s60, 524288
s_addc_u32 s61, s61, 0
s_setprio 3
s_barrier
ds_read_b128 v[28:31], v23
ds_read2st64_b32 v[12:13], v7 offset0:0 offset1:10
ds_read2st64_b32 v[14:15], v8 offset0:0 offset1:10
ds_read2st64_b32 v[16:17], v7 offset0:20 offset1:30
ds_read2st64_b32 v[18:19], v8 offset0:20 offset1:30
s_waitcnt lgkmcnt(2)
v_mul_f32 v12, v12, v28
v_fma_f32 v14, v14, v28, v24
v_fmac_f32 v12, v13, v29
v_fmac_f32 v14, v15, v29
s_waitcnt lgkmcnt(0)
v_fmac_f32 v12, v16, v30
v_fmac_f32 v14, v18, v30
v_fmac_f32 v12, v17, v31
v_fmac_f32 v14, v19, v31
v_cvt_pk_bf16_f32 v12, v12, v14
global_atomic_pk_add_bf16 v10, v9, v12, s[70:71] sc0
s_cmp_eq_u32 s64, 0
s_cbranch_scc1 Lnp_16_q
ds_read_b128 v[32:35], v20 offset:0
ds_read_b128 v[36:39], v20 offset:1024
ds_read_b128 v[24:27], v20 offset:6144
ds_read_b128 v[28:31], v20 offset:7168
s_waitcnt lgkmcnt(4)
Lnp_16_c:
v_max3_u32 v13, v43, v47, v51
v_max3_u32 v14, v55, v57, v59
v_max3_u32 v13, v61, v63, v13
v_max_u32 v13, v13, v14
v_cmp_eq_u32 vcc, -1, v13
s_cbranch_vccnz Lnp_16_r
s_waitcnt lgkmcnt(3)
v_mfma_f32_16x16x32_bf16 v[12:15], v[32:35], v[40:43], 0
ds_read2st64_b64 v[32:35], v20 offset0:4 offset1:16
s_waitcnt lgkmcnt(3)
v_mfma_f32_16x16x32_bf16 v[16:19], v[36:39], v[40:43], 0
ds_read2st64_b64 v[36:39], v21 offset0:4 offset1:16
s_waitcnt lgkmcnt(3)
v_mfma_f32_16x16x32_bf16 v[12:15], v[24:27], v[44:47], v[12:15]
ds_read_b128 v[24:27], v20 offset:12288
s_waitcnt lgkmcnt(3)
v_mfma_f32_16x16x32_bf16 v[16:19], v[28:31], v[44:47], v[16:19]
ds_read_b128 v[28:31], v20 offset:13312
s_waitcnt lgkmcnt(3)
v_mfma_f32_16x16x32_bf16 v[12:15], v[32:35], v[56:59], v[12:15]
ds_read_b128 v[32:35], v20 offset:18432
s_waitcnt lgkmcnt(3)
v_mfma_f32_16x16x32_bf16 v[16:19], v[36:39], v[56:59], v[16:19]
ds_read_b128 v[36:39], v20 offset:19456
s_waitcnt lgkmcnt(3)
v_mfma_f32_16x16x32_bf16 v[12:15], v[24:27], v[48:51], v[12:15]
ds_read2st64_b64 v[24:27], v20 offset0:28 offset1:40
s_waitcnt lgkmcnt(3)
v_mfma_f32_16x16x32_bf16 v[16:19], v[28:31], v[48:51], v[16:19]
ds_read2st64_b64 v[28:31], v21 offset0:28 offset1:40
s_waitcnt lgkmcnt(3)
v_mfma_f32_16x16x32_bf16 v[12:15], v[32:35], v[52:55], v[12:15]
s_waitcnt lgkmcnt(2)
v_mfma_f32_16x16x32_bf16 v[16:19], v[36:39], v[52:55], v[16:19]
s_waitcnt lgkmcnt(1)
v_mfma_f32_16x16x32_bf16 v[12:15], v[24:27], v[60:63], v[12:15]
s_waitcnt lgkmcnt(0)
v_mfma_f32_16x16x32_bf16 v[16:19], v[28:31], v[60:63], v[16:19]
s_nop 7
v_cvt_pk_bf16_f32 v19, v18, v19
v_cvt_pk_bf16_f32 v18, v16, v17
v_cvt_pk_bf16_f32 v16, v12, v13
v_cvt_pk_bf16_f32 v17, v14, v15
s_nop 0
v_permlane16_swap_b32 v16, v18
v_permlane16_swap_b32 v17, v19
v_min_u32 v19, -2, v19
Lnp_16_q:
v_lshl_add_u32 v15, v0, 4, s43
v_and_b32 v14, 15, v0
v_mul_u32_u24 v14, 12, v14
v_sub_u32 v14, v1, v14
s_cmp_ge_u32 s64, 63
s_cbranch_scc1 L1x_15
s_add_u32 s64, s64, 1
s_mov_b64 s[68:69], s[70:71]
s_add_u32 s70, s70, 20480
s_addc_u32 s71, s71, 0
s_mov_b64 s[50:51], s[72:73]
s_mov_b64 s[72:73], s[74:75]
s_mov_b64 s[74:75], s[50:51]
s_waitcnt vmcnt(0)
v_and_b32 v10, 0xffff0000, v10
v_cvt_u32_f32 v10, v10
s_nop 0
v_readlane_b32 s48, v10, 15
s_nop 0
s_lshl_b32 s48, s48, 2
s_lshr_b32 s48, 0x23579bd, s48
s_and_b32 s48, s48, 15
Lrank_19:
s_cbranch_scc0 L1_13
s_sleep 1
s_sub_u32 s48, s48, 1
s_cmp_lg_u32 s48, 0
s_branch Lrank_19
L1x_15:
global_store_dwordx4 v15, v[16:19], s[60:61] sc1
s_setprio 0
s_add_u32 s64, s64, 1
s_cmp_eq_u32 s64, 64
s_cbranch_scc1 Lnp_16_e
s_branch Lchain_done
LS2_6:
s_lshl_b32 s48, s56, 2
s_add_u32 s48, s48, s58
s_lshl_b32 s55, s48, 13
s_lshl_b32 s48, s48, 18
s_lshl_b32 s49, s57, 7
s_add_u32 s52, s48, s49
v_lshrrev_b32 v12, 3, v0
v_lshlrev_b32 v12, 11, v12
v_and_b32 v13, 7, v0
v_lshl_add_u32 v12, v13, 4, v12
s_lshl_b32 s53, s58, 13
s_add_u32 s53, s53, 131072
v_lshrrev_b32 v13, 4, v0
v_lshlrev_b32 v13, 3, v13
v_bfe_u32 v14, v0, 2, 2
v_add_u32 v13, v13, v14
v_lshlrev_b32 v13, 7, v13
v_and_b32 v14, 3, v0
v_lshl_add_u32 v13, v14, 3, v13
v_add_u32 v13, s53, v13
s_mov_b32 s40, s24
s_mov_b32 s41, s25
s_mov_b32 s42, 8388608
s_add_u32 s40, s40, s52
s_addc_u32 s41, s41, 0
s_sub_u32 s42, s42, s52
s_and_b32 s41, s41, 0xffff
s_mov_b32 s43, 0x20000
s_lshl_b32 s48, s56, 2
s_lshr_b32 s49, s57, 2
s_add_u32 s48, s48, s49
s_lshl_b32 s48, s48, 8
s_and_b32 s49, s57, 3
s_lshl_b32 s49, s49, 6
s_add_u32 s48, s48, s49
s_lshl_b32 s49, s58, 19
s_add_u32 s48, s48, s49
s_and_b32 s49, s57, 0
s_lshl_b32 s49, s49, 16
s_add_u32 s48, s48, s49
v_lshrrev_b32 v14, 2, v0
v_lshlrev_b32 v14, 13, v14
v_and_b32 v15, 3, v0
v_lshl_add_u32 v14, v15, 4, v14
s_mov_b32 s36, s22
s_mov_b32 s37, s23
s_mov_b32 s38, 8388608
s_add_u32 s36, s36, s48
s_addc_u32 s37, s37, 0
s_sub_u32 s38, s38, s48
s_and_b32 s37, s37, 0xffff
s_mov_b32 s39, 0x20000
s_mov_b32 s54, 0
Lvpf_20:
buffer_load_dwordx4 v[64:67], v14, s[36:39], s54 offen
s_add_u32 s54, s54, 131072
s_bitcmp1_b32 s54, 19
s_cselect_b32 s49, 1572864, 0
s_add_u32 s54, s54, s49
s_cmp_lt_u32 s54, 8388608
s_cbranch_scc1 Lvpf_20
s_waitcnt vmcnt(16)
s_cmp_lg_u32 s56, 0
s_cbranch_scc1 Lm0_21_n
s_cmp_gt_u32 s34, 4
s_cbranch_scc1 Lm0_21_n
v_and_b32 v24, v24, v26
v_and_b32 v25, v25, v27
v_lshl_or_b32 v24, v25, 16, v24
v_or_b32 v24, v24, v28
global_store_dword v9, v24, s[68:69] sc1
Lm0_21_n:
s_mov_b32 m0, s53
s_mov_b32 s54, 0
Lwo_22:
buffer_load_dwordx4 v12, s[40:43], s54 offen lds
s_add_u32 s54, s54, 16384
s_add_u32 m0, m0, 1024
s_cmp_lt_u32 s54, 131072
s_cbranch_scc1 Lwo_22
s_waitcnt vmcnt(8)
s_barrier
s_cmp_lg_u32 s34, 7
s_cbranch_scc1 La_23
s_getreg_b32 s48, hwreg(HW_REG_XCC_ID)
s_and_b32 s48, s48, 15
s_mul_i32 s49, s48, s48
s_lshl_b32 s49, s49, 8
s_add_u32 s48, s48, s49
s_lshl_b32 s48, s48, 8
s_add_u32 s48, s48, 1
s_lshl_b32 s49, s56, 2
s_mov_b64 exec, 1
v_mov_b32 v15, s49
v_mov_b32 v16, s48
global_atomic_add v15, v16, s[30:31] offset:4
s_mov_b64 exec, -1
La_23:
s_waitcnt vmcnt(0)
ds_read_b64_tr_b16 v[188:189], v13 offset:0
ds_read_b64_tr_b16 v[190:191], v13 offset:512
ds_read_b64_tr_b16 v[192:193], v13 offset:4096
ds_read_b64_tr_b16 v[194:195], v13 offset:4608
ds_read_b64_tr_b16 v[204:205], v13 offset:32
ds_read_b64_tr_b16 v[206:207], v13 offset:544
ds_read_b64_tr_b16 v[208:209], v13 offset:4128
ds_read_b64_tr_b16 v[210:211], v13 offset:4640
ds_read_b64_tr_b16 v[220:221], v13 offset:64
ds_read_b64_tr_b16 v[222:223], v13 offset:576
ds_read_b64_tr_b16 v[224:225], v13 offset:4160
ds_read_b64_tr_b16 v[226:227], v13 offset:4672
ds_read_b64_tr_b16 v[236:237], v13 offset:96
ds_read_b64_tr_b16 v[238:239], v13 offset:608
ds_read_b64_tr_b16 v[240:241], v13 offset:4192
ds_read_b64_tr_b16 v[242:243], v13 offset:4704
s_waitcnt lgkmcnt(0)
s_mov_b32 m0, s53
s_mov_b32 s54, 131072
Lwo_24:
buffer_load_dwordx4 v12, s[40:43], s54 offen lds
s_add_u32 s54, s54, 16384
s_add_u32 m0, m0, 1024
s_cmp_lt_u32 s54, 262144
s_cbranch_scc1 Lwo_24
s_waitcnt vmcnt(0)
ds_read_b64_tr_b16 v[196:197], v13 offset:0
ds_read_b64_tr_b16 v[198:199], v13 offset:512
ds_read_b64_tr_b16 v[200:201], v13 offset:4096
ds_read_b64_tr_b16 v[202:203], v13 offset:4608
ds_read_b64_tr_b16 v[212:213], v13 offset:32
ds_read_b64_tr_b16 v[214:215], v13 offset:544
ds_read_b64_tr_b16 v[216:217], v13 offset:4128
ds_read_b64_tr_b16 v[218:219], v13 offset:4640
ds_read_b64_tr_b16 v[228:229], v13 offset:64
ds_read_b64_tr_b16 v[230:231], v13 offset:576
ds_read_b64_tr_b16 v[232:233], v13 offset:4160
ds_read_b64_tr_b16 v[234:235], v13 offset:4672
ds_read_b64_tr_b16 v[244:245], v13 offset:96
ds_read_b64_tr_b16 v[246:247], v13 offset:608
ds_read_b64_tr_b16 v[248:249], v13 offset:4192
ds_read_b64_tr_b16 v[250:251], v13 offset:4704
s_waitcnt lgkmcnt(0)
s_mul_i32 s48, s58, 6144
v_lshlrev_b32 v14, 4, v0
v_add_u32 v1, s48, v14
v_add_u32 v20, s55, v14
s_lshl_b32 s49, s57, 9
s_add_u32 s55, s55, s49
s_add_u32 s55, s55, 524288
v_and_b32 v15, 15, v0
v_lshrrev_b32 v16, 2, v15
v_mul_u32_u24 v16, 160, v16
v_and_b32 v15, 3, v15
v_lshl_add_u32 v16, v15, 5, v16
v_bfe_u32 v15, v0, 4, 1
v_lshl_add_u32 v16, v15, 4, v16
s_mul_i32 s48, s58, 2560
s_add_u32 s48, s48, 18432
v_add_u32 v3, s48, v16
v_mov_b32 v24, 0x3f803f80
v_mov_b32 v25, 0x3f803f80
v_mov_b32 v26, 0x3f803f80
v_mov_b32 v27, 0x3f803f80
v_cmp_gt_u32 vcc, 32, v0
s_nop 1
v_cndmask_b32 v22, 0, v24, vcc
v_cndmask_b32 v23, 0, v24, vcc
v_and_b32 v15, 15, v0
v_lshrrev_b32 v16, 4, v0
s_mul_i32 s48, s58, 6144
s_add_u32 s48, s48, 32768
v_lshl_add_u32 v21, v0, 4, s48
s_and_b32 s48, s57, 3
s_lshl_b32 s49, s48, 3
v_lshlrev_b32 v16, 2, v16
v_sub_u32 v15, v15, v16
v_add_u32 v15, s49, v15
s_mov_b32 s40, 0xff00ff00
s_mov_b32 s41, 0xff00ff00
v_cndmask_b32 v252, v15, 64, s[40:41]
v_mov_b32 v253, 0xf149f2ca
s_lshr_b32 s49, s48, 1
s_and_b32 s48, s48, 1
s_lshl_b32 s48, s48, 7
s_lshl_b32 s60, s49, 12
s_add_u32 s60, s60, s48
s_sub_u32 s55, s55, s60
s_mul_i32 s42, s58, 3072
s_mul_i32 s43, s56, 12288
s_add_u32 s42, s42, s43
s_mul_i32 s43, s49, 1536
s_add_u32 s42, s42, s43
s_add_u32 s43, s42, s48
s_lshr_b32 s48, s48, 1
s_add_u32 s44, s42, s48
s_add_u32 s44, s44, 1024
s_lshr_b32 s45, s57, 2
s_mov_b32 s36, s32
s_mov_b32 s37, s33
s_mov_b32 s38, 268435456
s_and_b32 s37, s37, 0xffff
s_mov_b32 s39, 0x20000
v_bfe_u32 v254, v0, 2, 1
v_lshlrev_b32 v254, 6, v254
v_add_u32 v254, 28848, v254
v_and_b32 v255, 3, v0
v_cmp_eq_u32 vcc, 3, v255
s_nop 1
v_cndmask_b32 v255, 0, 1.0, vcc
v_add_u32 v19, 4096, v20
s_cmp_eq_u32 s45, s58
s_cselect_b32 s52, 0x00ff00ff, 0
s_mov_b32 s53, s52
v_and_b32 v12, 7, v0
v_lshlrev_b32 v12, 2, v12
Lws_25:
s_sleep 4
global_load_dword v14, v12, s[30:31] offset:4 sc1
s_add_u32 s65, s65, 1
s_cmp_gt_u32 s65, 400000
s_cbranch_scc1 Lcfail_1
s_waitcnt vmcnt(0)
Lws_25_c:
v_and_b32 v13, 255, v14
v_cmp_gt_u32 vcc, 16, v13
s_cbranch_vccnz Lws_25
v_readlane_b32 s48, v14, s56
s_nop 0
s_bfe_u32 s49, s48, 0x80008
s_mul_i32 s49, s49, s49
s_lshr_b32 s48, s48, 16
s_lshl_b32 s48, s48, 4
s_sub_u32 s66, s48, s49
s_barrier
s_mul_i32 s48, s58, 2560
s_add_u32 s48, s48, 18560
v_mov_b32 v12, s48
v_mov_b32 v14, 0x3e800000
v_mov_b32 v15, 0
ds_write_b64 v12, v[14:15]
s_cmp_lg_u32 s34, 4
s_cbranch_scc1 Lkvw_26
s_mov_b32 s49, 0
s_lshl_b32 s48, s49, 2
v_mov_b32 v12, s48
Lpoll_27:
global_load_dword v13, v12, s[30:31] offset:128 sc1
s_add_u32 s65, s65, 1
s_cmp_gt_u32 s65, 400000
s_cbranch_scc1 Lcfail_1
s_waitcnt vmcnt(0)
v_readfirstlane_b32 s48, v13
s_nop 0
s_cmp_ge_u32 s48, 96
s_cbranch_scc1 Lok_28
s_sleep 1
s_branch Lpoll_27
Lok_28:
Lkvw_26:
s_waitcnt lgkmcnt(0)
s_barrier
s_setprio 2
v_mov_b32 v14, s59
v_cmp_gt_u32 vcc, 32, v0
s_nop 1
v_cndmask_b32 v14, v14, 1.0, vcc
v_and_b32 v15, 15, v0
s_lshl_b32 s48, s58, 2
s_add_u32 s48, s48, 28672
v_lshl_add_u32 v15, v15, 4, s48
v_mov_b32 v16, 0
ds_write_b32 v15, v16 offset:256
ds_write_b32 v15, v16 offset:272
v_mov_b32 v16, 1
v_add_u32 v18, 4096, v1
s_or_b64 vcc, s[52:53], s[40:41]
v_mov_b32 v17, 0x3c000000
v_cndmask_b32 v17, -1, v17, vcc
s_mov_b32 s46, 0x21800000
global_load_dwordx4 v[156:159], v20, s[78:79] offset:0 sc1
global_load_dwordx4 v[160:163], v20, s[78:79] offset:1024 sc1
global_load_dwordx4 v[164:167], v20, s[78:79] offset:2048 sc1
global_load_dwordx4 v[168:171], v20, s[78:79] offset:3072 sc1
global_load_dwordx4 v[172:175], v19, s[78:79] offset:0 sc1
global_load_dwordx4 v[176:179], v19, s[78:79] offset:1024 sc1
global_load_dwordx4 v[180:183], v19, s[78:79] offset:2048 sc1
global_load_dwordx4 v[184:187], v19, s[78:79] offset:3072 sc1
global_load_dwordx4 v[124:127], v20, s[76:77] offset:0 sc1
global_load_dwordx4 v[128:131], v20, s[76:77] offset:1024 sc1
global_load_dwordx4 v[132:135], v20, s[76:77] offset:2048 sc1
global_load_dwordx4 v[136:139], v20, s[76:77] offset:3072 sc1
global_load_dwordx4 v[140:143], v19, s[76:77] offset:0 sc1
global_load_dwordx4 v[144:147], v19, s[76:77] offset:1024 sc1
global_load_dwordx4 v[148:151], v19, s[76:77] offset:2048 sc1
global_load_dwordx4 v[152:155], v19, s[76:77] offset:3072 sc1
s_mov_b64 exec, s[52:53]
buffer_load_dwordx4 v[88:91], v20, s[36:39], s60 offen offset:0 sc1
buffer_load_dwordx4 v[92:95], v20, s[36:39], s60 offen offset:1024 sc1
buffer_load_dwordx4 v[96:99], v20, s[36:39], s60 offen offset:2048 sc1
buffer_load_dwordx4 v[100:103], v20, s[36:39], s60 offen offset:3072 sc1
s_mov_b64 exec, -1
s_add_u32 s60, s60, 262144
s_waitcnt vmcnt(12) lgkmcnt(0)
v_mfma_f32_16x16x32_bf16 v[28:31], v[156:159], v[188:191], 0
v_mfma_f32_16x16x32_bf16 v[36:39], v[156:159], v[204:207], 0
v_mfma_f32_16x16x32_bf16 v[44:47], v[156:159], v[220:223], 0
v_mfma_f32_16x16x32_bf16 v[52:55], v[156:159], v[236:239], 0
v_mfma_f32_16x16x32_bf16 v[32:35], v[172:175], v[188:191], 0
v_mfma_f32_16x16x32_bf16 v[40:43], v[172:175], v[204:207], 0
v_mfma_f32_16x16x32_bf16 v[48:51], v[172:175], v[220:223], 0
v_mfma_f32_16x16x32_bf16 v[56:59], v[172:175], v[236:239], 0
v_mfma_f32_16x16x32_bf16 v[28:31], v[160:163], v[192:195], v[28:31]
v_mfma_f32_16x16x32_bf16 v[36:39], v[160:163], v[208:211], v[36:39]
v_mfma_f32_16x16x32_bf16 v[44:47], v[160:163], v[224:227], v[44:47]
v_mfma_f32_16x16x32_bf16 v[52:55], v[160:163], v[240:243], v[52:55]
v_mfma_f32_16x16x32_bf16 v[32:35], v[176:179], v[192:195], v[32:35]
v_mfma_f32_16x16x32_bf16 v[40:43], v[176:179], v[208:211], v[40:43]
v_mfma_f32_16x16x32_bf16 v[48:51], v[176:179], v[224:227], v[48:51]
v_mfma_f32_16x16x32_bf16 v[56:59], v[176:179], v[240:243], v[56:59]
v_mfma_f32_16x16x32_bf16 v[28:31], v[164:167], v[196:199], v[28:31]
v_mfma_f32_16x16x32_bf16 v[36:39], v[164:167], v[212:215], v[36:39]
v_mfma_f32_16x16x32_bf16 v[44:47], v[164:167], v[228:231], v[44:47]
v_mfma_f32_16x16x32_bf16 v[52:55], v[164:167], v[244:247], v[52:55]
v_mfma_f32_16x16x32_bf16 v[32:35], v[180:183], v[196:199], v[32:35]
v_mfma_f32_16x16x32_bf16 v[40:43], v[180:183], v[212:215], v[40:43]
v_mfma_f32_16x16x32_bf16 v[48:51], v[180:183], v[228:231], v[48:51]
v_mfma_f32_16x16x32_bf16 v[56:59], v[180:183], v[244:247], v[56:59]
v_mfma_f32_16x16x32_bf16 v[28:31], v[168:171], v[200:203], v[28:31]
v_mfma_f32_16x16x32_bf16 v[36:39], v[168:171], v[216:219], v[36:39]
v_mfma_f32_16x16x32_bf16 v[44:47], v[168:171], v[232:235], v[44:47]
v_mfma_f32_16x16x32_bf16 v[52:55], v[168:171], v[248:251], v[52:55]
v_mfma_f32_16x16x32_bf16 v[32:35], v[184:187], v[200:203], v[32:35]
v_mfma_f32_16x16x32_bf16 v[40:43], v[184:187], v[216:219], v[40:43]
v_mfma_f32_16x16x32_bf16 v[48:51], v[184:187], v[232:235], v[48:51]
v_mfma_f32_16x16x32_bf16 v[56:59], v[184:187], v[248:251], v[56:59]
s_nop 0
v_cvt_pk_bf16_f32 v108, v28, v29
v_cvt_pk_bf16_f32 v109, v30, v31
s_nop 1
v_cvt_pk_bf16_f32 v110, v32, v33
v_cvt_pk_bf16_f32 v111, v34, v35
v_cvt_pk_bf16_f32 v112, v36, v37
v_cvt_pk_bf16_f32 v113, v38, v39
v_cvt_pk_bf16_f32 v114, v40, v41
v_cvt_pk_bf16_f32 v115, v42, v43
v_cvt_pk_bf16_f32 v116, v44, v45
v_cvt_pk_bf16_f32 v117, v46, v47
v_cvt_pk_bf16_f32 v118, v48, v49
v_cvt_pk_bf16_f32 v119, v50, v51
v_cvt_pk_bf16_f32 v120, v52, v53
v_cvt_pk_bf16_f32 v121, v54, v55
v_cvt_pk_bf16_f32 v122, v56, v57
v_cvt_pk_bf16_f32 v123, v58, v59
v_mov_b64 v[72:73], 0
v_mov_b64 v[74:75], 0
v_mov_b64 v[76:77], 0
v_mov_b64 v[78:79], 0
v_mov_b64 v[80:81], 0
v_mov_b64 v[82:83], 0
v_mov_b64 v[84:85], 0
v_mov_b64 v[86:87], 0
v_cmp_gt_i32 vcc, 0, v252
v_cmp_gt_i32 s[48:49], 1, v252
v_cmp_gt_i32 s[50:51], 2, v252
v_cmp_gt_i32 s[54:55], 3, v252
v_cndmask_b32 v52, 0, v253, vcc
v_cndmask_b32 v53, 0, v253, s[48:49]
v_cndmask_b32 v54, 0, v253, s[50:51]
v_cndmask_b32 v55, 0, v253, s[54:55]
v_cmp_gt_i32 vcc, 16, v252
v_cmp_gt_i32 s[48:49], 17, v252
v_cmp_gt_i32 s[50:51], 18, v252
v_cmp_gt_i32 s[54:55], 19, v252
v_cndmask_b32 v56, 0, v253, vcc
v_cndmask_b32 v57, 0, v253, s[48:49]
v_cndmask_b32 v58, 0, v253, s[50:51]
v_cndmask_b32 v59, 0, v253, s[54:55]
s_add_u32 s78, s78, 262144
s_addc_u32 s79, s79, 0
s_add_u32 s76, s76, 262144
s_addc_u32 s77, s77, 0
global_load_dwordx4 v[156:159], v20, s[78:79] offset:0 sc1
global_load_dwordx4 v[160:163], v20, s[78:79] offset:1024 sc1
global_load_dwordx4 v[164:167], v20, s[78:79] offset:2048 sc1
global_load_dwordx4 v[168:171], v20, s[78:79] offset:3072 sc1
global_load_dwordx4 v[172:175], v19, s[78:79] offset:0 sc1
global_load_dwordx4 v[176:179], v19, s[78:79] offset:1024 sc1
global_load_dwordx4 v[180:183], v19, s[78:79] offset:2048 sc1
global_load_dwordx4 v[184:187], v19, s[78:79] offset:3072 sc1
s_add_u32 s78, s78, 262144
s_addc_u32 s79, s79, 0
.p2align 6
s_nop 0
s_nop 0
s_nop 0
s_nop 0
s_nop 0
s_nop 0
L2_29:
s_barrier
ds_read2st64_b32 v[28:29], v4 offset0:0 offset1:18
ds_read2st64_b32 v[30:31], v5 offset0:0 offset1:18
ds_read2st64_b32 v[32:33], v4 offset0:36 offset1:54
ds_read2st64_b32 v[34:35], v5 offset0:36 offset1:54
s_cmp_lg_u32 s66, 0
s_waitcnt lgkmcnt(2)
v_add_f32 v28, v28, v29
v_add_f32 v30, v30, v31
v_mul_f32 v28, v28, v14
v_mul_f32 v30, v30, v14
s_waitcnt lgkmcnt(0)
v_add_f32 v32, v32, v33
v_add_f32 v34, v34, v35
v_fmac_f32 v28, v32, v14
v_fmac_f32 v30, v34, v14
v_cvt_pk_bf16_f32 v28, v28, v30
v_min_u32 v28, -2, v28
s_cbranch_scc1 Lslow_32
global_store_dword v6, v28, s[72:73]
global_store_dword v6, v11, s[74:75]
Lback_33:
s_waitcnt vmcnt(0)
LpB_30:
global_load_dwordx4 v[28:31], v1, s[72:73] offset:0 sc1
global_load_dwordx4 v[32:35], v1, s[72:73] offset:1024 sc1
global_load_dwordx4 v[36:39], v1, s[72:73] offset:2048 sc1
global_load_dwordx4 v[40:43], v1, s[72:73] offset:3072 sc1
global_load_dwordx4 v[44:47], v18, s[72:73] offset:0 sc1
global_load_dwordx4 v[48:51], v18, s[72:73] offset:1024 sc1
LpB_30_c0:
s_waitcnt vmcnt(5)
v_cmp_eq_u32 vcc, -1, v31
v_cndmask_b32 v88, v88, v28, s[40:41]
v_cndmask_b32 v89, v89, v29, s[40:41]
v_cndmask_b32 v90, v90, v30, s[40:41]
v_cndmask_b32 v91, v91, v31, s[40:41]
s_cbranch_vccnz LpB_30_r0
s_nop 0
v_mfma_f32_16x16x32_bf16 v[52:55], v[124:127], v[88:91], v[52:55]
LpB_30_c1:
s_waitcnt vmcnt(4)
v_cmp_eq_u32 vcc, -1, v35
v_cndmask_b32 v92, v92, v32, s[40:41]
s_cbranch_vccnz LpB_30_r1
v_mfma_f32_16x16x32_bf16 v[56:59], v[140:143], v[88:91], v[56:59]
v_cndmask_b32 v93, v93, v33, s[40:41]
v_cndmask_b32 v94, v94, v34, s[40:41]
v_cndmask_b32 v95, v95, v35, s[40:41]
v_mfma_f32_16x16x32_bf16 v[60:63], v[28:31], v[88:91], 0
s_nop 0
v_mfma_f32_16x16x32_bf16 v[52:55], v[128:131], v[92:95], v[52:55]
LpB_30_c2:
s_waitcnt vmcnt(3)
v_cmp_eq_u32 vcc, -1, v39
v_cndmask_b32 v96, v96, v36, s[40:41]
s_cbranch_vccnz LpB_30_r2
v_mfma_f32_16x16x32_bf16 v[56:59], v[144:147], v[92:95], v[56:59]
v_cndmask_b32 v97, v97, v37, s[40:41]
v_cndmask_b32 v98, v98, v38, s[40:41]
v_cndmask_b32 v99, v99, v39, s[40:41]
v_mfma_f32_16x16x32_bf16 v[60:63], v[32:35], v[92:95], v[60:63]
s_nop 0
v_mfma_f32_16x16x32_bf16 v[52:55], v[132:135], v[96:99], v[52:55]
LpB_30_c3:
s_waitcnt vmcnt(2)
v_cmp_eq_u32 vcc, -1, v43
v_cndmask_b32 v100, v100, v40, s[40:41]
s_cbranch_vccnz LpB_30_r3
v_mfma_f32_16x16x32_bf16 v[56:59], v[148:151], v[96:99], v[56:59]
v_cndmask_b32 v101, v101, v41, s[40:41]
v_cndmask_b32 v102, v102, v42, s[40:41]
v_cndmask_b32 v103, v103, v43, s[40:41]
v_mfma_f32_16x16x32_bf16 v[60:63], v[36:39], v[96:99], v[60:63]
s_nop 0
v_mfma_f32_16x16x32_bf16 v[52:55], v[136:139], v[100:103], v[52:55]
v_mfma_f32_16x16x32_bf16 v[56:59], v[152:155], v[100:103], v[56:59]
v_mfma_f32_16x16x32_bf16 v[60:63], v[40:43], v[100:103], v[60:63]
LpB_30_c4:
s_waitcnt vmcnt(1)
v_cmp_eq_u32 vcc, -1, v47
s_cbranch_vccnz LpB_30_r4
v_smfmac_f32_16x16x64_bf16 v[72:75], v[44:47], v[188:195], v2
v_smfmac_f32_16x16x64_bf16 v[76:79], v[44:47], v[204:211], v2
s_nop 0
v_exp_f32 v28, v52
v_smfmac_f32_16x16x64_bf16 v[80:83], v[44:47], v[220:227], v2
v_exp_f32 v29, v53
v_smfmac_f32_16x16x64_bf16 v[84:87], v[44:47], v[236:243], v2
v_exp_f32 v30, v54
LpB_30_c5:
s_waitcnt vmcnt(0)
v_cmp_eq_u32 vcc, -1, v51
v_exp_f32 v31, v55
s_cbranch_vccnz LpB_30_r5
v_smfmac_f32_16x16x64_bf16 v[72:75], v[48:51], v[196:203], v2
ds_write_b32 v15, v16 offset:256
v_exp_f32 v32, v56
v_smfmac_f32_16x16x64_bf16 v[76:79], v[48:51], v[212:219], v2
v_exp_f32 v33, v57
v_smfmac_f32_16x16x64_bf16 v[80:83], v[48:51], v[228:235], v2
v_exp_f32 v34, v58
v_smfmac_f32_16x16x64_bf16 v[84:87], v[48:51], v[244:251], v2
v_exp_f32 v35, v59
v_cvt_pk_bf16_f32 v64, v28, v29
v_cvt_pk_bf16_f32 v65, v30, v31
v_cvt_pk_bf16_f32 v66, v32, v33
v_cvt_pk_bf16_f32 v67, v34, v35
v_exp_f32 v36, v60
global_load_dwordx4 v[124:127], v20, s[76:77] offset:0 sc1
v_mfma_f32_16x16x32_bf16 v[88:91], v[64:67], v[108:111], 0
v_exp_f32 v37, v61
v_mfma_f32_16x16x32_bf16 v[92:95], v[64:67], v[112:115], 0
v_exp_f32 v38, v62
v_mfma_f32_16x16x32_bf16 v[96:99], v[64:67], v[116:119], 0
v_exp_f32 v39, v63
v_mfma_f32_16x16x32_bf16 v[100:103], v[64:67], v[120:123], 0
v_cvt_pk_bf16_f32 v68, v36, v37
v_cvt_pk_bf16_f32 v69, v38, v39
v_mfma_f32_16x16x32_bf16 v[104:107], v[24:27], v[64:67], 0
v_mov_b32 v70, v68
v_mov_b32 v71, v69
v_cvt_pk_bf16_f32 v72, v72, v73
v_cvt_pk_bf16_f32 v73, v74, v75
v_permlane32_swap_b32 v68, v70
v_permlane32_swap_b32 v69, v71
v_cvt_pk_bf16_f32 v74, v76, v77
v_cvt_pk_bf16_f32 v75, v78, v79
v_mfma_f32_16x16x16_bf16 v[88:91], v[68:69], v[72:73], v[88:91]
v_cvt_pk_bf16_f32 v76, v80, v81
v_cvt_pk_bf16_f32 v77, v82, v83
v_mfma_f32_16x16x16_bf16 v[104:107], v[22:23], v[68:69], v[104:107]
v_cvt_pk_bf16_f32 v78, v84, v85
v_cvt_pk_bf16_f32 v79, v86, v87
v_mfma_f32_16x16x16_bf16 v[92:95], v[68:69], v[74:75], v[92:95]
global_load_dwordx4 v[128:131], v20, s[76:77] offset:1024 sc1
v_mfma_f32_16x16x16_bf16 v[96:99], v[68:69], v[76:77], v[96:99]
global_load_dwordx4 v[132:135], v20, s[76:77] offset:2048 sc1
v_mfma_f32_16x16x16_bf16 v[100:103], v[68:69], v[78:79], v[100:103]
global_load_dwordx4 v[136:139], v20, s[76:77] offset:3072 sc1
v_rcp_f32 v105, v104
s_mov_b32 exec_lo, 0
ds_write_b128 v3, v[88:91] offset:0
ds_write_b128 v3, v[92:95] offset:640
s_nop 0
ds_write_b128 v3, v[96:99] offset:1280
s_nop 0
ds_write_b128 v3, v[100:103] offset:1920
s_mov_b32 exec_lo, -1
ds_write_b32 v15, v105
v_subrev_u32 v10, s46, v104
v_cmp_lt_u32 vcc, v17, v10
global_load_dwordx4 v[140:143], v19, s[76:77] offset:0 sc1
global_load_dwordx4 v[144:147], v19, s[76:77] offset:1024 sc1
global_load_dwordx4 v[148:151], v19, s[76:77] offset:2048 sc1
global_load_dwordx4 v[152:155], v19, s[76:77] offset:3072 sc1
s_cbranch_vccnz Lfb_34
Lfb_34_b:
s_waitcnt lgkmcnt(0)
s_barrier
s_cmp_lg_u32 s34, 4
s_cbranch_scc1 Lna_35
s_mov_b64 exec, 0xffff
ds_read_b128 v[52:55], v254
ds_read2st64_b32 v[44:45], v7 offset0:0 offset1:10
ds_read2st64_b32 v[46:47], v8 offset0:0 offset1:10
ds_read2st64_b32 v[48:49], v7 offset0:20 offset1:30
ds_read2st64_b32 v[50:51], v8 offset0:20 offset1:30
s_waitcnt lgkmcnt(2)
v_mul_f32 v44, v44, v52
v_fma_f32 v46, v46, v52, v255
v_fmac_f32 v44, v45, v53
v_fmac_f32 v46, v47, v53
s_waitcnt lgkmcnt(0)
v_fmac_f32 v44, v48, v54
v_fmac_f32 v46, v50, v54
v_fmac_f32 v44, v49, v55
v_fmac_f32 v46, v51, v55
v_cvt_pk_bf16_f32 v44, v44, v46
global_atomic_pk_add_bf16 v9, v44, s[70:71]
s_mov_b64 exec, -1
Lna_35:
s_cmp_eq_u32 s45, s58
s_cbranch_scc1 Lxp_36
Lv_37:
s_cmp_eq_u32 s64, 63
s_cbranch_scc1 L2x_31
s_add_u32 s63, s64, 2
s_and_b32 s63, s63, 63
s_and_b32 s48, s63, 3
s_cbranch_scc1 Lkvw_38
v_mov_b32 v10, s63
global_load_dword v10, v10, s[30:31] offset:128 sc1
Lkvw_38:
v_mfma_f32_16x16x32_bf16 v[28:31], v[156:159], v[188:191], 0
v_mfma_f32_16x16x32_bf16 v[36:39], v[156:159], v[204:207], 0
v_mfma_f32_16x16x32_bf16 v[44:47], v[156:159], v[220:223], 0
v_mfma_f32_16x16x32_bf16 v[52:55], v[156:159], v[236:239], 0
v_mfma_f32_16x16x32_bf16 v[32:35], v[172:175], v[188:191], 0
v_mfma_f32_16x16x32_bf16 v[40:43], v[172:175], v[204:207], 0
v_mfma_f32_16x16x32_bf16 v[48:51], v[172:175], v[220:223], 0
ds_write_b128 v21, v[108:111] offset:0
v_mfma_f32_16x16x32_bf16 v[56:59], v[172:175], v[236:239], 0
v_mfma_f32_16x16x32_bf16 v[28:31], v[160:163], v[192:195], v[28:31]
s_mov_b64 exec, s[52:53]
buffer_load_dwordx4 v[88:91], v20, s[36:39], s60 offen offset:0 sc1
buffer_load_dwordx4 v[92:95], v20, s[36:39], s60 offen offset:1024 sc1
buffer_load_dwordx4 v[96:99], v20, s[36:39], s60 offen offset:2048 sc1
buffer_load_dwordx4 v[100:103], v20, s[36:39], s60 offen offset:3072 sc1
s_mov_b64 exec, -1
s_add_u32 s60, s60, 262144
v_mfma_f32_16x16x32_bf16 v[36:39], v[160:163], v[208:211], v[36:39]
v_mfma_f32_16x16x32_bf16 v[44:47], v[160:163], v[224:227], v[44:47]
ds_write_b128 v21, v[112:115] offset:1024
v_mfma_f32_16x16x32_bf16 v[52:55], v[160:163], v[240:243], v[52:55]
v_mfma_f32_16x16x32_bf16 v[32:35], v[176:179], v[192:195], v[32:35]
v_mfma_f32_16x16x32_bf16 v[40:43], v[176:179], v[208:211], v[40:43]
v_mfma_f32_16x16x32_bf16 v[48:51], v[176:179], v[224:227], v[48:51]
ds_write_b128 v21, v[116:119] offset:3072
v_mfma_f32_16x16x32_bf16 v[56:59], v[176:179], v[240:243], v[56:59]
v_mfma_f32_16x16x32_bf16 v[28:31], v[164:167], v[196:199], v[28:31]
v_mfma_f32_16x16x32_bf16 v[36:39], v[164:167], v[212:215], v[36:39]
v_mfma_f32_16x16x32_bf16 v[44:47], v[164:167], v[228:231], v[44:47]
ds_write_b128 v21, v[120:123] offset:4096
v_mfma_f32_16x16x32_bf16 v[52:55], v[164:167], v[244:247], v[52:55]
v_mfma_f32_16x16x32_bf16 v[32:35], v[180:183], v[196:199], v[32:35]
v_mfma_f32_16x16x32_bf16 v[40:43], v[180:183], v[212:215], v[40:43]
v_mfma_f32_16x16x32_bf16 v[48:51], v[180:183], v[228:231], v[48:51]
ds_write_b128 v21, v[72:75] offset:2048
v_mfma_f32_16x16x32_bf16 v[56:59], v[180:183], v[244:247], v[56:59]
v_mfma_f32_16x16x32_bf16 v[28:31], v[168:171], v[200:203], v[28:31]
v_mfma_f32_16x16x32_bf16 v[36:39], v[168:171], v[216:219], v[36:39]
v_mfma_f32_16x16x32_bf16 v[44:47], v[168:171], v[232:235], v[44:47]
ds_write_b128 v21, v[76:79] offset:5120
v_mfma_f32_16x16x32_bf16 v[52:55], v[168:171], v[248:251], v[52:55]
v_mfma_f32_16x16x32_bf16 v[32:35], v[184:187], v[200:203], v[32:35]
v_mfma_f32_16x16x32_bf16 v[40:43], v[184:187], v[216:219], v[40:43]
v_mfma_f32_16x16x32_bf16 v[48:51], v[184:187], v[232:235], v[48:51]
v_mfma_f32_16x16x32_bf16 v[56:59], v[184:187], v[248:251], v[56:59]
v_mov_b64 v[72:73], 0
v_mov_b64 v[74:75], 0
v_mov_b64 v[76:77], 0
v_mov_b64 v[78:79], 0
v_mov_b64 v[80:81], 0
v_mov_b64 v[82:83], 0
v_mov_b64 v[84:85], 0
v_mov_b64 v[86:87], 0
v_cvt_pk_bf16_f32 v108, v28, v29
v_cvt_pk_bf16_f32 v109, v30, v31
v_cvt_pk_bf16_f32 v110, v32, v33
v_cvt_pk_bf16_f32 v111, v34, v35
v_cvt_pk_bf16_f32 v112, v36, v37
v_cvt_pk_bf16_f32 v113, v38, v39
v_cvt_pk_bf16_f32 v114, v40, v41
v_cvt_pk_bf16_f32 v115, v42, v43
v_cvt_pk_bf16_f32 v116, v44, v45
v_cvt_pk_bf16_f32 v117, v46, v47
v_cvt_pk_bf16_f32 v118, v48, v49
v_cvt_pk_bf16_f32 v119, v50, v51
v_cvt_pk_bf16_f32 v120, v52, v53
v_cvt_pk_bf16_f32 v121, v54, v55
v_cvt_pk_bf16_f32 v122, v56, v57
v_cvt_pk_bf16_f32 v123, v58, v59
v_cmp_gt_i32 vcc, 0, v252
v_cmp_gt_i32 s[48:49], 1, v252
v_cmp_gt_i32 s[50:51], 2, v252
v_cmp_gt_i32 s[54:55], 3, v252
v_cndmask_b32 v52, 0, v253, vcc
v_cndmask_b32 v53, 0, v253, s[48:49]
v_cndmask_b32 v54, 0, v253, s[50:51]
v_cndmask_b32 v55, 0, v253, s[54:55]
v_cmp_gt_i32 vcc, 16, v252
v_cmp_gt_i32 s[48:49], 17, v252
v_cmp_gt_i32 s[50:51], 18, v252
v_cmp_gt_i32 s[54:55], 19, v252
v_cndmask_b32 v56, 0, v253, vcc
v_cndmask_b32 v57, 0, v253, s[48:49]
v_cndmask_b32 v58, 0, v253, s[50:51]
v_cndmask_b32 v59, 0, v253, s[54:55]
s_and_b32 s48, s63, 3
s_cbranch_scc1 Lkvw_39
s_waitcnt vmcnt(4)
v_readfirstlane_b32 s48, v10
s_nop 0
s_cmp_ge_u32 s48, 96
s_cbranch_scc1 Lkvw_39
s_lshr_b32 s49, s63, 2
s_lshl_b32 s48, s49, 2
v_mov_b32 v12, s48
Lpoll_40:
global_load_dword v13, v12, s[30:31] offset:128 sc1
s_add_u32 s65, s65, 1
s_cmp_gt_u32 s65, 400000
s_cbranch_scc1 Lcfail_1
s_waitcnt vmcnt(0)
v_readfirstlane_b32 s48, v13
s_nop 0
s_cmp_ge_u32 s48, 96
s_cbranch_scc1 Lok_41
s_sleep 4
s_branch Lpoll_40
Lok_41:
Lkvw_39:
v_and_b32 v12, 3, v0
v_lshlrev_b32 v12, 2, v12
Lfl_42:
s_sleep 1
ds_read_b32 v13, v12 offset:29248
s_add_u32 s65, s65, 1
s_cmp_gt_u32 s65, 400000
s_cbranch_scc1 Lcfail_1
s_waitcnt lgkmcnt(0)
v_cmp_eq_u32 vcc, s64, v13
s_cbranch_vccnz Lfl_42
global_load_dwordx4 v[156:159], v20, s[78:79] offset:0 sc1
global_load_dwordx4 v[172:175], v19, s[78:79] offset:0 sc1
global_load_dwordx4 v[160:163], v20, s[78:79] offset:1024 sc1
global_load_dwordx4 v[176:179], v19, s[78:79] offset:1024 sc1
global_load_dwordx4 v[164:167], v20, s[78:79] offset:2048 sc1
global_load_dwordx4 v[180:183], v19, s[78:79] offset:2048 sc1
global_load_dwordx4 v[168:171], v20, s[78:79] offset:3072 sc1
global_load_dwordx4 v[184:187], v19, s[78:79] offset:3072 sc1
v_add_u32 v16, 1, v16
s_add_u32 s78, s78, 262144
s_addc_u32 s79, s79, 0
s_add_u32 s76, s76, 262144
s_addc_u32 s77, s77, 0
v_xor_b32 v21, 98304, v21
s_add_u32 s64, s64, 1
s_mov_b64 s[68:69], s[70:71]
s_add_u32 s70, s70, 20480
s_addc_u32 s71, s71, 0
s_mov_b64 s[50:51], s[72:73]
s_mov_b64 s[72:73], s[74:75]
s_mov_b64 s[74:75], s[50:51]
s_branch L2_29
.p2align 6
LpA_14_retry:
s_nop 7
s_sleep 0
global_load_dword v39, v14, s[68:69] offset:1024 sc1
global_load_dwordx4 v[20:23], v1, s[68:69] offset:0 sc1
global_load_dwordx4 v[24:27], v1, s[68:69] offset:256 sc1
global_load_dwordx4 v[28:31], v1, s[68:69] offset:512 sc1
global_load_dwordx4 v[32:35], v1, s[68:69] offset:768 sc1
s_branch LpA_14_j
Lslow_17:
global_store_dword v6, v24, s[72:73] sc1
global_store_dword v6, v11, s[74:75] sc1
s_branch Lback_18
Lnp_16_o:
s_sleep 9
s_lshl_b32 s48, s35, 3
s_add_u32 s48, s48, s34
s_cmp_lg_u32 s48, 2
s_cbranch_scc1 Lnp_16
v_mov_b32 v20, 0
v_mov_b32 v21, s64
s_mov_b64 exec, 1
global_store_dword v20, v21, s[30:31] offset:64 sc1
s_mov_b64 exec, -1
s_branch Lnp_16
Lnp_16_f:
s_barrier
s_add_u32 s60, s60, 524288
s_addc_u32 s61, s61, 0
ds_read_b128 v[32:35], v20 offset:0
ds_read_b128 v[36:39], v20 offset:1024
ds_read_b128 v[24:27], v20 offset:6144
ds_read_b128 v[28:31], v20 offset:7168
s_branch Lnp_16_r
Lnp_16_r:
v_lshlrev_b32 v18, 4, v0
v_lshlrev_b32 v19, 3, v0
buffer_load_dwordx4 v[40:43], v18, s[36:39], s44 offen offset:0 sc1
buffer_load_dwordx2 v[56:57], v19, s[36:39], s40 offen offset:0 sc1
buffer_load_dwordx4 v[44:47], v18, s[36:39], s44 offen offset:3072 sc1
buffer_load_dwordx2 v[58:59], v19, s[36:39], s40 offen offset:3072 sc1
buffer_load_dwordx4 v[48:51], v18, s[36:39], s45 offen offset:0 sc1
buffer_load_dwordx2 v[60:61], v19, s[36:39], s41 offen offset:0 sc1
buffer_load_dwordx4 v[52:55], v18, s[36:39], s45 offen offset:3072 sc1
buffer_load_dwordx2 v[62:63], v19, s[36:39], s41 offen offset:3072 sc1
s_add_u32 s65, s65, 1
s_cmp_gt_u32 s65, 400000
s_cbranch_scc1 Lcfail_1
s_waitcnt vmcnt(0)
s_branch Lnp_16_c
Lslow_32:
global_store_dword v6, v28, s[72:73] sc1
global_store_dword v6, v11, s[74:75] sc1
s_branch Lback_33
LpB_30_r0:
global_load_dwordx4 v[28:31], v1, s[72:73] offset:0 sc1
global_load_dwordx4 v[32:35], v1, s[72:73] offset:1024 sc1
global_load_dwordx4 v[36:39], v1, s[72:73] offset:2048 sc1
global_load_dwordx4 v[40:43], v1, s[72:73] offset:3072 sc1
global_load_dwordx4 v[44:47], v18, s[72:73] offset:0 sc1
global_load_dwordx4 v[48:51], v18, s[72:73] offset:1024 sc1
s_add_u32 s65, s65, 1
s_cmp_gt_u32 s65, 400000
s_cbranch_scc1 Lcfail_1
s_branch LpB_30_c0
LpB_30_r1:
global_load_dwordx4 v[32:35], v1, s[72:73] offset:1024 sc1
global_load_dwordx4 v[36:39], v1, s[72:73] offset:2048 sc1
global_load_dwordx4 v[40:43], v1, s[72:73] offset:3072 sc1
global_load_dwordx4 v[44:47], v18, s[72:73] offset:0 sc1
global_load_dwordx4 v[48:51], v18, s[72:73] offset:1024 sc1
s_add_u32 s65, s65, 1
s_cmp_gt_u32 s65, 400000
s_cbranch_scc1 Lcfail_1
s_branch LpB_30_c1
LpB_30_r2:
global_load_dwordx4 v[36:39], v1, s[72:73] offset:2048 sc1
global_load_dwordx4 v[40:43], v1, s[72:73] offset:3072 sc1
global_load_dwordx4 v[44:47], v18, s[72:73] offset:0 sc1
global_load_dwordx4 v[48:51], v18, s[72:73] offset:1024 sc1
s_add_u32 s65, s65, 1
s_cmp_gt_u32 s65, 400000
s_cbranch_scc1 Lcfail_1
s_branch LpB_30_c2
LpB_30_r3:
global_load_dwordx4 v[40:43], v1, s[72:73] offset:3072 sc1
global_load_dwordx4 v[44:47], v18, s[72:73] offset:0 sc1
global_load_dwordx4 v[48:51], v18, s[72:73] offset:1024 sc1
s_add_u32 s65, s65, 1
s_cmp_gt_u32 s65, 400000
s_cbranch_scc1 Lcfail_1
s_branch LpB_30_c3
LpB_30_r4:
global_load_dwordx4 v[44:47], v18, s[72:73] offset:0 sc1
global_load_dwordx4 v[48:51], v18, s[72:73] offset:1024 sc1
s_add_u32 s65, s65, 1
s_cmp_gt_u32 s65, 400000
s_cbranch_scc1 Lcfail_1
s_branch LpB_30_c4
LpB_30_r5:
global_load_dwordx4 v[48:51], v18, s[72:73] offset:1024 sc1
s_add_u32 s65, s65, 1
s_cmp_gt_u32 s65, 400000
s_cbranch_scc1 Lcfail_1
s_branch LpB_30_c5
Lfb_34:
v_max3_f32 v12, v52, v53, v54
v_max3_f32 v13, v55, v56, v57
v_max3_f32 v12, v58, v59, v12
v_max_f32 v12, v12, v13
s_mov_b32 exec_hi, 0
v_max3_f32 v12, v60, v61, v12
v_max3_f32 v12, v62, v63, v12
s_mov_b32 exec_hi, -1
v_mov_b32 v13, v12
s_nop 1
v_permlane16_swap_b32 v12, v13
v_max_f32 v12, v12, v13
v_mov_b32 v13, v12
s_nop 1
v_permlane32_swap_b32 v12, v13
v_max_f32 v12, v12, v13
v_sub_f32 v52, v52, v12
v_sub_f32 v53, v53, v12
v_sub_f32 v54, v54, v12
v_sub_f32 v55, v55, v12
v_sub_f32 v56, v56, v12
v_sub_f32 v57, v57, v12
v_sub_f32 v58, v58, v12
v_sub_f32 v59, v59, v12
v_sub_f32 v60, v60, v12
v_sub_f32 v61, v61, v12
v_sub_f32 v62, v62, v12
v_sub_f32 v63, v63, v12
v_exp_f32 v28, v52
v_exp_f32 v29, v53
v_exp_f32 v30, v54
v_exp_f32 v31, v55
v_exp_f32 v32, v56
v_exp_f32 v33, v57
v_exp_f32 v34, v58
v_exp_f32 v35, v59
v_exp_f32 v36, v60
v_exp_f32 v37, v61
v_exp_f32 v38, v62
v_exp_f32 v39, v63
v_cvt_pk_bf16_f32 v64, v28, v29
v_cvt_pk_bf16_f32 v65, v30, v31
v_cvt_pk_bf16_f32 v66, v32, v33
v_cvt_pk_bf16_f32 v67, v34, v35
v_cvt_pk_bf16_f32 v68, v36, v37
v_cvt_pk_bf16_f32 v69, v38, v39
v_mov_b32 v70, v68
v_mov_b32 v71, v69
s_nop 0
v_permlane32_swap_b32 v68, v70
v_permlane32_swap_b32 v69, v71
v_mfma_f32_16x16x32_bf16 v[104:107], v[24:27], v[64:67], 0
v_mfma_f32_16x16x32_bf16 v[88:91], v[64:67], v[108:111], 0
v_mfma_f32_16x16x32_bf16 v[92:95], v[64:67], v[112:115], 0
v_mfma_f32_16x16x32_bf16 v[96:99], v[64:67], v[116:119], 0
v_mfma_f32_16x16x32_bf16 v[100:103], v[64:67], v[120:123], 0
s_nop 1
v_mfma_f32_16x16x16_bf16 v[104:107], v[22:23], v[68:69], v[104:107]
v_mfma_f32_16x16x16_bf16 v[88:91], v[68:69], v[72:73], v[88:91]
v_mfma_f32_16x16x16_bf16 v[92:95], v[68:69], v[74:75], v[92:95]
v_mfma_f32_16x16x16_bf16 v[96:99], v[68:69], v[76:77], v[96:99]
v_mfma_f32_16x16x16_bf16 v[100:103], v[68:69], v[78:79], v[100:103]
s_nop 3
v_rcp_f32 v105, v104
s_mov_b32 exec_lo, 0
ds_write_b128 v3, v[88:91] offset:0
ds_write_b128 v3, v[92:95] offset:640
ds_write_b128 v3, v[96:99] offset:1280
ds_write_b128 v3, v[100:103] offset:1920
s_mov_b32 exec_lo, -1
ds_write_b32 v15, v105
s_branch Lfb_34_b
Lxp_36:
v_mul_f32 v36, v36, v105
v_mul_f32 v37, v37, v105
v_mul_f32 v38, v38, v105
v_mul_f32 v39, v39, v105
v_mul_f32 v28, v28, v105
v_mul_f32 v29, v29, v105
v_mul_f32 v30, v30, v105
v_mul_f32 v31, v31, v105
v_mul_f32 v32, v32, v105
v_mul_f32 v33, v33, v105
v_mul_f32 v34, v34, v105
v_mul_f32 v35, v35, v105
v_cvt_pk_bf16_f32 v68, v36, v37
v_cvt_pk_bf16_f32 v69, v38, v39
v_cvt_pk_bf16_f32 v64, v28, v29
v_mov_b32 v70, v68
v_mov_b32 v71, v69
v_cvt_pk_bf16_f32 v65, v30, v31
v_cvt_pk_bf16_f32 v66, v32, v33
v_permlane32_swap_b32 v68, v70
v_permlane32_swap_b32 v69, v71
v_cvt_pk_bf16_f32 v67, v34, v35
Lxp_36_t:
v_lshl_add_u32 v12, v0, 4, s43
v_lshl_add_u32 v13, v0, 3, s44
s_and_b32 s48, s64, 3
s_mul_i32 s48, s48, 98304
s_add_u32 s48, s48, 83361792
s_add_u32 s49, s64, 1
s_and_b32 s49, s49, 3
s_mul_i32 s49, s49, 98304
s_add_u32 s49, s49, 83361792
v_mov_b64 v[60:61], -1
v_mov_b64 v[62:63], -1
s_not_b64 exec, s[40:41]
s_cmp_lg_u32 s66, 0
s_cbranch_scc1 Lxp_36_s
buffer_store_dwordx4 v[64:67], v12, s[36:39], s48 offen
buffer_store_dwordx2 v[68:69], v13, s[36:39], s48 offen
buffer_store_dwordx4 v[60:63], v12, s[36:39], s49 offen
buffer_store_dwordx2 v[60:61], v13, s[36:39], s49 offen
s_mov_b64 exec, -1
s_branch Lv_37
Lxp_36_s:
buffer_store_dwordx4 v[64:67], v12, s[36:39], s48 offen sc1
buffer_store_dwordx2 v[68:69], v13, s[36:39], s48 offen sc1
buffer_store_dwordx4 v[60:63], v12, s[36:39], s49 offen sc1
buffer_store_dwordx2 v[60:61], v13, s[36:39], s49 offen sc1
s_mov_b64 exec, -1
s_branch Lv_37
L2x_31:
ds_write_b128 v21, v[108:111] offset:0
ds_write_b128 v21, v[112:115] offset:1024
ds_write_b128 v21, v[116:119] offset:3072
ds_write_b128 v21, v[120:123] offset:4096
ds_write_b128 v21, v[72:75] offset:2048
ds_write_b128 v21, v[76:79] offset:5120
s_waitcnt lgkmcnt(0)
s_barrier
s_setprio 0
s_branch Lchain_done
Lcfail_1:
s_mov_b64 exec, -1
v_mov_b32 v12, 0
v_mov_b32 v13, 1
global_store_dword v12, v13, s[30:31] offset:80
s_endpgm
Lchain_done:
s_waitcnt vmcnt(0)
s_endpgm
Lworker:
s_add_u32 s35, s70, 128
s_mov_b32 s79, 0
s_mov_b32 s71, 0
s_waitcnt vmcnt(0)
v_mov_b32 v1, v90
s_and_b32 s48, s70, 31
s_lshl_b32 s48, s48, 3
s_add_u32 s48, s48, s34
s_lshl_b32 s48, s48, 10
v_lshl_add_u32 v2, v0, 4, s48
global_load_dwordx4 v[88:91], v2, s[14:15]
v_add_u32 v2, 0x40000, v2
global_load_dwordx4 v[88:91], v2, s[14:15]
v_add_u32 v2, 0x40000, v2
s_and_b32 s48, s70, 31
s_lshl_b32 s48, s48, 2
s_lshr_b32 s49, s34, 1
s_add_u32 s48, s48, s49
s_lshl_b32 s48, s48, 16
v_lshrrev_b32 v2, 3, v0
v_lshlrev_b32 v2, 13, v2
v_and_b32 v3, 7, v0
v_lshl_add_u32 v2, v3, 4, v2
v_add_u32 v2, s48, v2
s_lshr_b32 s50, s70, 5
s_mul_i32 s50, s50, 6
s_and_b32 s49, s34, 1
s_add_u32 s50, s50, s49
s_lshr_b32 s53, s50, 3
s_and_b32 s54, s50, 7
s_lshl_b32 s54, s54, 10
s_cmp_eq_u32 s53, 1
s_cselect_b32 s56, s20, s18
s_cselect_b32 s57, s21, s19
s_cmp_eq_u32 s53, 2
s_cselect_b32 s56, s22, s56
s_cselect_b32 s57, s23, s57
s_add_u32 s56, s56, s54
s_addc_u32 s57, s57, 0
global_load_dwordx4 v[88:91], v2, s[56:57] offset:384
s_cmp_lg_u32 s54, 7168
s_cbranch_scc1 Lwpf0
global_load_dwordx4 v[88:91], v2, s[56:57] offset:896
Lwpf0:
s_add_u32 s50, s50, 2
s_lshr_b32 s53, s50, 3
s_and_b32 s54, s50, 7
s_lshl_b32 s54, s54, 10
s_cmp_eq_u32 s53, 1
s_cselect_b32 s56, s20, s18
s_cselect_b32 s57, s21, s19
s_cmp_eq_u32 s53, 2
s_cselect_b32 s56, s22, s56
s_cselect_b32 s57, s23, s57
s_add_u32 s56, s56, s54
s_addc_u32 s57, s57, 0
global_load_dwordx4 v[88:91], v2, s[56:57] offset:384
s_cmp_lg_u32 s54, 7168
s_cbranch_scc1 Lwpf1
global_load_dwordx4 v[88:91], v2, s[56:57] offset:896
Lwpf1:
s_add_u32 s50, s50, 2
s_lshr_b32 s53, s50, 3
s_and_b32 s54, s50, 7
s_lshl_b32 s54, s54, 10
s_cmp_eq_u32 s53, 1
s_cselect_b32 s56, s20, s18
s_cselect_b32 s57, s21, s19
s_cmp_eq_u32 s53, 2
s_cselect_b32 s56, s22, s56
s_cselect_b32 s57, s23, s57
s_add_u32 s56, s56, s54
s_addc_u32 s57, s57, 0
global_load_dwordx4 v[88:91], v2, s[56:57] offset:384
s_cmp_lg_u32 s54, 7168
s_cbranch_scc1 Lwpf2
global_load_dwordx4 v[88:91], v2, s[56:57] offset:896
Lwpf2:
s_add_u32 s50, s50, 2
Lnext:
v_readlane_b32 s73, v1, s71
s_add_u32 s71, s71, 1
s_lshr_b32 s76, s73, 16
s_bfe_u32 s72, s73, 0x80008
s_and_b32 s73, s73, 255
Ldisp:
s_cmp_eq_u32 s76, 1
s_cbranch_scc1 Ljob1
s_cmp_eq_u32 s76, 2
s_cbranch_scc1 Ljob2
s_cmp_eq_u32 s76, 3
s_cbranch_scc1 Ljob3
s_cmp_eq_u32 s76, 4
s_cbranch_scc1 Ljob4
s_cmp_eq_u32 s76, 5
s_cbranch_scc1 Ljob5
s_cmp_eq_u32 s76, 7
s_cbranch_scc1 Ljob7
s_cmp_eq_u32 s76, 0
s_cbranch_scc1 Ljob0
Ljob6:
s_mul_i32 s52, s72, 262144
s_mov_b32 s36, s14
s_mov_b32 s37, s15
s_mov_b32 s38, 4194304
s_add_u32 s36, s36, s52
s_addc_u32 s37, s37, 0
s_sub_u32 s38, s38, s52
s_and_b32 s37, s37, 0xffff
s_mov_b32 s39, 0x20000
s_lshr_b32 s53, s73, 5
s_and_b32 s54, s73, 31
s_cmp_eq_u32 s53, 1
s_cselect_b32 s56, s20, s18
s_cselect_b32 s57, s21, s19
s_cmp_eq_u32 s53, 2
s_cselect_b32 s56, s22, s56
s_cselect_b32 s57, s23, s57
s_lshl_b32 s52, s54, 8
s_mov_b32 s40, s56
s_mov_b32 s41, s57
s_mov_b32 s42, 8388608
s_add_u32 s40, s40, s52
s_addc_u32 s41, s41, 0
s_sub_u32 s42, s42, s52
s_and_b32 s41, s41, 0xffff
s_mov_b32 s43, 0x20000
s_lshr_b32 s48, s34, 2
s_and_b32 s49, s34, 3
s_mul_i32 s50, s34, 16
v_lshrrev_b32 v20, 3, v0
v_add_u32 v20, s50, v20
v_lshrrev_b32 v21, 1, v20
v_xor_b32 v21, v21, v0
v_and_b32 v21, 7, v21
v_lshlrev_b32 v21, 4, v21
v_mul_u32_u24 v20, 2048, v20
v_add_u32 v2, v20, v21
v_xor_b32 v21, 64, v21
v_add_u32 v21, v20, v21
v_add_u32 v3, 15360, v21
s_lshl_b32 s50, s34, 3
s_add_u32 s50, s50, 0
v_lshrrev_b32 v20, 4, v0
v_add_u32 v20, s50, v20
v_and_b32 v21, 3, v20
v_lshlrev_b32 v21, 2, v21
v_bfe_u32 v22, v20, 3, 1
v_lshl_or_b32 v21, v22, 1, v21
v_and_b32 v22, 15, v0
v_xor_b32 v21, v21, v22
v_mul_u32_u24 v20, 8192, v20
v_lshl_add_u32 v20, v21, 4, v20
v_subrev_u32 v4, 0, v20
s_lshl_b32 s50, s34, 3
s_add_u32 s50, s50, 4
v_lshrrev_b32 v20, 4, v0
v_add_u32 v20, s50, v20
v_and_b32 v21, 3, v20
v_lshlrev_b32 v21, 2, v21
v_bfe_u32 v22, v20, 3, 1
v_lshl_or_b32 v21, v22, 1, v21
v_and_b32 v22, 15, v0
v_xor_b32 v21, v21, v22
v_mul_u32_u24 v20, 8192, v20
v_lshl_add_u32 v20, v21, 4, v20
v_subrev_u32 v5, 1024, v20
s_mul_i32 s67, s34, 2048
s_mul_i32 s68, s34, 2048
s_add_u32 s68, s68, 81920
s_mul_i32 s65, s35, 1
s_and_b32 s65, s65, 1
s_mul_i32 s64, s65, 128
s_mul_i32 s65, s65, 524288
s_mov_b32 s92, 128
s_mov_b32 s93, 524288
s_mov_b32 s69, 0
Lpro_43:
s_add_u32 s69, s69, 1
s_cmp_eq_u32 s69, 5
s_cselect_b32 s69, 0, s69
s_mov_b32 s62, 16384
s_cselect_b32 s62, 0xffff0000, s62
s_mov_b32 s63, 16384
s_cselect_b32 s63, 0xffff0000, s63
s_mov_b32 m0, s67
s_nop 0
buffer_load_dwordx4 v2, s[36:39], s64 offen offset:0  lds
buffer_load_dwordx4 v3, s[36:39], s64 offen offset:1024  lds
s_add_u32 s67, s67, s62
s_add_u32 s64, s64, s92
s_and_b32 s64, s64, 2047
s_cmp_eq_u32 s69, 0
s_cbranch_scc1 Lprox_44
s_mov_b32 m0, s68
s_nop 0
buffer_load_dwordx4 v4, s[40:43], s65 offen offset:0 lds
buffer_load_dwordx4 v5, s[40:43], s65 offen offset:1024 lds
s_add_u32 s68, s68, s63
s_add_u32 s65, s65, s93
s_and_b32 s65, s65, 8388607
s_branch Lpro_43
Lprox_44:
s_lshr_b32 s48, s34, 2
s_and_b32 s49, s34, 3
s_mul_i32 s50, s48, 8192
v_and_b32 v20, 15, v0
v_bfe_u32 v21, v0, 1, 3
v_lshrrev_b32 v22, 4, v0
v_xor_b32 v21, v21, v22
v_lshlrev_b32 v21, 4, v21
v_lshlrev_b32 v20, 7, v20
v_add_u32 v20, s50, v20
v_xor_b32 v22, 0, v21
v_add_u32 v6, v20, v22
v_xor_b32 v22, 64, v21
v_add_u32 v7, v20, v22
v_bfe_u32 v20, v0, 2, 2
v_lshrrev_b32 v21, 4, v0
v_lshl_add_u32 v21, v21, 3, v20
v_mul_u32_u24 v21, 256, v21
v_and_b32 v22, 3, v0
v_lshl_add_u32 v21, v22, 3, v21
v_add_u32 v21, 81920, v21
v_bfe_u32 v22, v0, 4, 1
v_lshl_or_b32 v20, v20, 1, v22
s_mul_i32 s50, s49, 2
s_add_u32 s51, s50, 0
v_xor_b32 v22, s51, v20
v_lshl_add_u32 v8, v22, 5, v21
s_add_u32 s51, s50, 1
v_xor_b32 v22, s51, v20
v_lshl_add_u32 v9, v22, 5, v21
v_mov_b64 v[128:129], 0
v_mov_b64 v[130:131], 0
v_mov_b64 v[132:133], 0
v_mov_b64 v[134:135], 0
v_mov_b64 v[136:137], 0
v_mov_b64 v[138:139], 0
v_mov_b64 v[140:141], 0
v_mov_b64 v[142:143], 0
v_mov_b64 v[144:145], 0
v_mov_b64 v[146:147], 0
v_mov_b64 v[148:149], 0
v_mov_b64 v[150:151], 0
v_mov_b64 v[152:153], 0
v_mov_b64 v[154:155], 0
v_mov_b64 v[156:157], 0
v_mov_b64 v[158:159], 0
s_mov_b32 s77, 0
s_waitcnt vmcnt(14)
s_barrier
ds_read_b64_tr_b16 v[56:57], v8 offset:0
ds_read_b64_tr_b16 v[58:59], v8 offset:1024
ds_read_b128 v[24:27], v6 offset:0
ds_read_b128 v[28:31], v6 offset:2048
ds_read_b128 v[32:35], v6 offset:4096
ds_read_b128 v[36:39], v6 offset:6144
ds_read_b64_tr_b16 v[60:61], v9 offset:0
ds_read_b64_tr_b16 v[62:63], v9 offset:1024
s_mov_b32 s66, 0
s_branch Lgn_50
.p2align 6
Lg_45:
s_waitcnt vmcnt(12) lgkmcnt(0)
s_barrier
Lgb_46:
v_mfma_f32_16x16x32_bf16 v[128:131], v[64:67], v[40:43], v[128:131]
ds_read_b64_tr_b16 v[56:57], v8 offset:0
ds_read_b64_tr_b16 v[58:59], v8 offset:1024
v_mfma_f32_16x16x32_bf16 v[132:135], v[64:67], v[44:47], v[132:135]
ds_read_b128 v[24:27], v6 offset:0
ds_read_b128 v[28:31], v6 offset:2048
v_mfma_f32_16x16x32_bf16 v[136:139], v[64:67], v[48:51], v[136:139]
s_mov_b32 m0, s67
s_nop 0
buffer_load_dwordx4 v2, s[36:39], s64 offen offset:0  lds
ds_read_b128 v[32:35], v6 offset:4096
v_mfma_f32_16x16x32_bf16 v[140:143], v[64:67], v[52:55], v[140:143]
ds_read_b128 v[36:39], v6 offset:6144
ds_read_b64_tr_b16 v[60:61], v9 offset:0
v_mfma_f32_16x16x32_bf16 v[144:147], v[68:71], v[40:43], v[144:147]
ds_read_b64_tr_b16 v[62:63], v9 offset:1024
buffer_load_dwordx4 v3, s[36:39], s64 offen offset:1024  lds
s_add_u32 s67, s67, s62
s_add_u32 s64, s64, s92
s_and_b32 s64, s64, 2047
v_mfma_f32_16x16x32_bf16 v[148:151], v[68:71], v[44:47], v[148:151]
s_add_u32 s66, s66, 1
s_cmp_eq_u32 s66, 16
v_mfma_f32_16x16x32_bf16 v[152:155], v[68:71], v[48:51], v[152:155]
v_mfma_f32_16x16x32_bf16 v[156:159], v[68:71], v[52:55], v[156:159]
s_cbranch_scc1 Lge_52
Lgn_50:
s_waitcnt lgkmcnt(0)
v_mfma_f32_16x16x32_bf16 v[128:131], v[56:59], v[24:27], v[128:131]
ds_read_b64_tr_b16 v[64:65], v8 offset:8192
ds_read_b64_tr_b16 v[66:67], v8 offset:9216
v_mfma_f32_16x16x32_bf16 v[132:135], v[56:59], v[28:31], v[132:135]
ds_read_b128 v[40:43], v7 offset:0
ds_read_b128 v[44:47], v7 offset:2048
v_mfma_f32_16x16x32_bf16 v[136:139], v[56:59], v[32:35], v[136:139]
s_mov_b32 m0, s68
s_nop 0
buffer_load_dwordx4 v4, s[40:43], s65 offen offset:0 lds
ds_read_b128 v[48:51], v7 offset:4096
v_mfma_f32_16x16x32_bf16 v[140:143], v[56:59], v[36:39], v[140:143]
ds_read_b128 v[52:55], v7 offset:6144
ds_read_b64_tr_b16 v[68:69], v9 offset:8192
v_mfma_f32_16x16x32_bf16 v[144:147], v[60:63], v[24:27], v[144:147]
ds_read_b64_tr_b16 v[70:71], v9 offset:9216
buffer_load_dwordx4 v5, s[40:43], s65 offen offset:1024 lds
s_add_u32 s68, s68, s63
s_add_u32 s65, s65, s93
s_and_b32 s65, s65, 8388607
v_mfma_f32_16x16x32_bf16 v[148:151], v[60:63], v[28:31], v[148:151]
s_add_u32 s69, s69, 1
s_cmp_eq_u32 s69, 5
s_cselect_b32 s69, 0, s69
s_mov_b32 s62, 16384
s_cselect_b32 s62, 0xffff0000, s62
s_mov_b32 s63, 16384
s_cselect_b32 s63, 0xffff0000, s63
v_add_u32 v6, s62, v6
v_mfma_f32_16x16x32_bf16 v[152:155], v[60:63], v[32:35], v[152:155]
v_add_u32 v7, s62, v7
v_add_u32 v8, s63, v8
v_mfma_f32_16x16x32_bf16 v[156:159], v[60:63], v[36:39], v[156:159]
v_add_u32 v9, s63, v9
s_cmp_eq_u32 s66, 11
s_cbranch_scc1 Lgs_48
Lgsb_49:
s_cmp_eq_u32 s77, 0
s_cbranch_scc1 Lg_45
s_branch Lgh_47
Lge_52:
s_mov_b32 s66, 0
s_cmp_ge_u32 s75, 32
s_cbranch_scc1 Lqs_53
s_mov_b32 s58, 0x3e0293ee
s_nop 7
v_pk_mul_f32 v[128:129], v[128:129], s[58:59] op_sel_hi:[1,0]
v_pk_mul_f32 v[130:131], v[130:131], s[58:59] op_sel_hi:[1,0]
v_pk_mul_f32 v[132:133], v[132:133], s[58:59] op_sel_hi:[1,0]
v_pk_mul_f32 v[134:135], v[134:135], s[58:59] op_sel_hi:[1,0]
v_pk_mul_f32 v[136:137], v[136:137], s[58:59] op_sel_hi:[1,0]
v_pk_mul_f32 v[138:139], v[138:139], s[58:59] op_sel_hi:[1,0]
v_pk_mul_f32 v[140:141], v[140:141], s[58:59] op_sel_hi:[1,0]
v_pk_mul_f32 v[142:143], v[142:143], s[58:59] op_sel_hi:[1,0]
v_pk_mul_f32 v[144:145], v[144:145], s[58:59] op_sel_hi:[1,0]
v_pk_mul_f32 v[146:147], v[146:147], s[58:59] op_sel_hi:[1,0]
v_pk_mul_f32 v[148:149], v[148:149], s[58:59] op_sel_hi:[1,0]
v_pk_mul_f32 v[150:151], v[150:151], s[58:59] op_sel_hi:[1,0]
v_pk_mul_f32 v[152:153], v[152:153], s[58:59] op_sel_hi:[1,0]
v_pk_mul_f32 v[154:155], v[154:155], s[58:59] op_sel_hi:[1,0]
v_pk_mul_f32 v[156:157], v[156:157], s[58:59] op_sel_hi:[1,0]
v_pk_mul_f32 v[158:159], v[158:159], s[58:59] op_sel_hi:[1,0]
Lqs_53:
s_lshr_b32 s58, s75, 5
s_lshl_b32 s58, s58, 24
s_mul_i32 s59, s74, 1048576
s_add_u32 s58, s58, s59
s_and_b32 s59, s75, 31
s_lshl_b32 s59, s59, 13
s_add_u32 s58, s58, s59
s_mov_b32 s44, s32
s_mov_b32 s45, s33
s_mov_b32 s46, 268435456
s_add_u32 s44, s44, s58
s_addc_u32 s45, s45, 0
s_sub_u32 s46, s46, s58
s_and_b32 s45, s45, 0xffff
s_mov_b32 s47, 0x20000
s_lshr_b32 s60, s34, 2
s_and_b32 s61, s34, 3
s_mul_i32 s58, s61, 1
s_lshr_b32 s59, s58, 2
s_lshl_b32 s59, s59, 13
s_and_b32 s58, s58, 3
s_lshl_b32 s58, s58, 10
s_add_u32 s58, s58, s59
s_mul_i32 s59, s60, 524288
s_add_u32 s58, s58, s59
v_and_b32 v92, 15, v0
v_lshlrev_b32 v92, 4, v92
v_bfe_u32 v93, v0, 4, 1
v_lshl_add_u32 v92, v93, 9, v92
v_lshrrev_b32 v93, 5, v0
v_lshl_add_u32 v92, v93, 8, v92
v_cvt_pk_bf16_f32 v96, v128, v129
v_cvt_pk_bf16_f32 v97, v130, v131
v_cvt_pk_bf16_f32 v98, v144, v145
v_cvt_pk_bf16_f32 v99, v146, v147
s_nop 0
v_permlane16_swap_b32 v96, v98
v_permlane16_swap_b32 v97, v99
buffer_store_dwordx4 v[96:99], v92, s[44:47], s58 offen offset:0 sc1
v_cvt_pk_bf16_f32 v100, v132, v133
v_cvt_pk_bf16_f32 v101, v134, v135
v_cvt_pk_bf16_f32 v102, v148, v149
v_cvt_pk_bf16_f32 v103, v150, v151
s_nop 0
v_permlane16_swap_b32 v100, v102
v_permlane16_swap_b32 v101, v103
s_add_u32 s58, s58, 4096
buffer_store_dwordx4 v[100:103], v92, s[44:47], s58 offen offset:0 sc1
v_cvt_pk_bf16_f32 v104, v136, v137
v_cvt_pk_bf16_f32 v105, v138, v139
v_cvt_pk_bf16_f32 v106, v152, v153
v_cvt_pk_bf16_f32 v107, v154, v155
s_nop 0
v_permlane16_swap_b32 v104, v106
v_permlane16_swap_b32 v105, v107
s_add_u32 s58, s58, 258048
buffer_store_dwordx4 v[104:107], v92, s[44:47], s58 offen offset:0 sc1
v_cvt_pk_bf16_f32 v108, v140, v141
v_cvt_pk_bf16_f32 v109, v142, v143
v_cvt_pk_bf16_f32 v110, v156, v157
v_cvt_pk_bf16_f32 v111, v158, v159
s_nop 0
v_permlane16_swap_b32 v108, v110
v_permlane16_swap_b32 v109, v111
s_add_u32 s58, s58, 4096
buffer_store_dwordx4 v[108:111], v92, s[44:47], s58 offen offset:0 sc1
v_mov_b64 v[128:129], 0
v_mov_b64 v[130:131], 0
v_mov_b64 v[132:133], 0
v_mov_b64 v[134:135], 0
v_mov_b64 v[136:137], 0
v_mov_b64 v[138:139], 0
v_mov_b64 v[140:141], 0
v_mov_b64 v[142:143], 0
v_mov_b64 v[144:145], 0
v_mov_b64 v[146:147], 0
v_mov_b64 v[148:149], 0
v_mov_b64 v[150:151], 0
v_mov_b64 v[152:153], 0
v_mov_b64 v[154:155], 0
v_mov_b64 v[156:157], 0
v_mov_b64 v[158:159], 0
s_mov_b32 s61, s74
s_mov_b32 s77, 1
s_cmp_eq_u32 s76, 6
s_cbranch_scc1 Lgn_50
s_branch Lgx_51
Lgs_48:
s_mov_b32 s74, s72
s_mov_b32 s75, s73
v_readlane_b32 s73, v1, s71
s_add_u32 s71, s71, 1
s_lshr_b32 s76, s73, 16
s_bfe_u32 s72, s73, 0x80008
s_and_b32 s73, s73, 255
s_mul_i32 s52, s72, 262144
s_mov_b32 s36, s14
s_mov_b32 s37, s15
s_mov_b32 s38, 4194304
s_add_u32 s36, s36, s52
s_addc_u32 s37, s37, 0
s_sub_u32 s38, s38, s52
s_and_b32 s37, s37, 0xffff
s_mov_b32 s39, 0x20000
s_lshr_b32 s53, s73, 5
s_and_b32 s54, s73, 31
s_cmp_eq_u32 s53, 1
s_cselect_b32 s56, s20, s18
s_cselect_b32 s57, s21, s19
s_cmp_eq_u32 s53, 2
s_cselect_b32 s56, s22, s56
s_cselect_b32 s57, s23, s57
s_lshl_b32 s52, s54, 8
s_mov_b32 s40, s56
s_mov_b32 s41, s57
s_mov_b32 s42, 8388608
s_add_u32 s40, s40, s52
s_addc_u32 s41, s41, 0
s_sub_u32 s42, s42, s52
s_and_b32 s41, s41, 0xffff
s_mov_b32 s43, 0x20000
s_cmp_eq_u32 s76, 6
s_cbranch_scc1 Lsw_54
s_mov_b32 s38, 0
s_mov_b32 s42, 0
Lsw_54:
s_sub_u32 s92, 0, s92
s_sub_u32 s93, 0, s93
s_add_u32 s64, s64, s92
s_and_b32 s64, s64, 2047
s_add_u32 s65, s65, s93
s_and_b32 s65, s65, 8388607
s_branch Lgsb_49
Lgh_47:
s_sub_u32 s77, s77, 1
s_cmp_eq_u32 s77, 0
s_cbranch_scc1 Lgst_55
s_waitcnt vmcnt(16) lgkmcnt(0)
s_barrier
s_branch Lgb_46
Lgst_55:
s_waitcnt vmcnt(2) lgkmcnt(0)
s_barrier
s_cmp_lg_u32 s34, 0
s_cbranch_scc1 Lsig_56
s_lshl_b32 s58, s61, 2
v_lshl_add_u32 v92, v0, 2, s58
v_mov_b32 v93, 1
s_mov_b64 exec, 1
global_atomic_add v92, v93, s[30:31] offset:128
s_mov_b64 exec, -1
Lsig_56:
s_branch Lgb_46
Lgx_51:
s_waitcnt vmcnt(0) lgkmcnt(0)
s_barrier
s_cmp_lg_u32 s34, 0
s_cbranch_scc1 Lsig_57
s_lshl_b32 s58, s61, 2
v_lshl_add_u32 v92, v0, 2, s58
v_mov_b32 v93, 1
s_mov_b64 exec, 1
global_atomic_add v92, v93, s[30:31] offset:128
s_mov_b64 exec, -1
Lsig_57:
s_branch Ldisp
Ljob1:
s_mul_i32 s52, s72, 524288
s_mov_b32 s36, s14
s_mov_b32 s37, s15
s_mov_b32 s38, 4194304
s_add_u32 s36, s36, s52
s_addc_u32 s37, s37, 0
s_sub_u32 s38, s38, s52
s_and_b32 s37, s37, 0xffff
s_mov_b32 s39, 0x20000
s_lshr_b32 s53, s73, 5
s_and_b32 s54, s73, 31
s_cmp_eq_u32 s53, 1
s_cselect_b32 s56, s20, s18
s_cselect_b32 s57, s21, s19
s_cmp_eq_u32 s53, 2
s_cselect_b32 s56, s22, s56
s_cselect_b32 s57, s23, s57
s_lshl_b32 s52, s54, 8
s_mov_b32 s40, s56
s_mov_b32 s41, s57
s_mov_b32 s42, 8388608
s_add_u32 s40, s40, s52
s_addc_u32 s41, s41, 0
s_sub_u32 s42, s42, s52
s_and_b32 s41, s41, 0xffff
s_mov_b32 s43, 0x20000
s_lshr_b32 s48, s34, 1
s_and_b32 s49, s34, 1
s_mul_i32 s50, s34, 32
v_lshrrev_b32 v20, 3, v0
v_add_u32 v20, s50, v20
v_lshrrev_b32 v21, 1, v20
v_xor_b32 v21, v21, v0
v_and_b32 v21, 7, v21
v_lshlrev_b32 v21, 4, v21
v_mul_u32_u24 v20, 2048, v20
v_add_u32 v2, v20, v21
v_xor_b32 v21, 64, v21
v_add_u32 v21, v20, v21
v_add_u32 v3, 15360, v21
v_add_u32 v4, 30720, v2
v_add_u32 v5, 46080, v21
s_lshl_b32 s50, s34, 3
s_add_u32 s50, s50, 0
v_lshrrev_b32 v20, 4, v0
v_add_u32 v20, s50, v20
v_and_b32 v21, 3, v20
v_lshlrev_b32 v21, 2, v21
v_bfe_u32 v22, v20, 3, 1
v_lshl_or_b32 v21, v22, 1, v21
v_and_b32 v22, 15, v0
v_xor_b32 v21, v21, v22
v_mul_u32_u24 v20, 8192, v20
v_lshl_add_u32 v20, v21, 4, v20
v_subrev_u32 v6, 0, v20
s_lshl_b32 s50, s34, 3
s_add_u32 s50, s50, 4
v_lshrrev_b32 v20, 4, v0
v_add_u32 v20, s50, v20
v_and_b32 v21, 3, v20
v_lshlrev_b32 v21, 2, v21
v_bfe_u32 v22, v20, 3, 1
v_lshl_or_b32 v21, v22, 1, v21
v_and_b32 v22, 15, v0
v_xor_b32 v21, v21, v22
v_mul_u32_u24 v20, 8192, v20
v_lshl_add_u32 v20, v21, 4, v20
v_subrev_u32 v7, 1024, v20
s_mul_i32 s67, s34, 4096
s_mul_i32 s68, s34, 2048
s_add_u32 s68, s68, 98304
s_mul_i32 s65, s35, 1
s_and_b32 s65, s65, 15
s_mul_i32 s64, s65, 128
s_mul_i32 s65, s65, 524288
s_mov_b32 s92, 128
s_mov_b32 s93, 524288
s_mov_b32 s69, 0
Lpro_58:
s_add_u32 s69, s69, 1
s_cmp_eq_u32 s69, 3
s_cselect_b32 s69, 0, s69
s_mov_b32 s62, 32768
s_cselect_b32 s62, 0xffff0000, s62
s_mov_b32 s63, 16384
s_cselect_b32 s63, 0xffff8000, s63
s_mov_b32 m0, s67
s_nop 0
buffer_load_dwordx4 v2, s[36:39], s64 offen offset:0  lds
buffer_load_dwordx4 v3, s[36:39], s64 offen offset:1024  lds
buffer_load_dwordx4 v4, s[36:39], s64 offen offset:2048  lds
buffer_load_dwordx4 v5, s[36:39], s64 offen offset:3072  lds
s_add_u32 s67, s67, s62
s_add_u32 s64, s64, s92
s_and_b32 s64, s64, 2047
s_cmp_eq_u32 s69, 0
s_cbranch_scc1 Lprox_59
s_mov_b32 m0, s68
s_nop 0
buffer_load_dwordx4 v6, s[40:43], s65 offen offset:0 lds
buffer_load_dwordx4 v7, s[40:43], s65 offen offset:1024 lds
s_add_u32 s68, s68, s63
s_add_u32 s65, s65, s93
s_and_b32 s65, s65, 8388607
s_branch Lpro_58
Lprox_59:
s_lshr_b32 s48, s34, 1
s_and_b32 s49, s34, 1
s_mul_i32 s50, s48, 8192
v_and_b32 v20, 15, v0
v_bfe_u32 v21, v0, 1, 3
v_lshrrev_b32 v22, 4, v0
v_xor_b32 v21, v21, v22
v_lshlrev_b32 v21, 4, v21
v_lshlrev_b32 v20, 7, v20
v_add_u32 v20, s50, v20
v_xor_b32 v22, 0, v21
v_add_u32 v8, v20, v22
v_xor_b32 v22, 64, v21
v_add_u32 v9, v20, v22
v_bfe_u32 v20, v0, 2, 2
v_lshrrev_b32 v21, 4, v0
v_lshl_add_u32 v21, v21, 3, v20
v_mul_u32_u24 v21, 256, v21
v_and_b32 v22, 3, v0
v_lshl_add_u32 v21, v22, 3, v21
v_add_u32 v21, 98304, v21
v_bfe_u32 v22, v0, 4, 1
v_lshl_or_b32 v20, v20, 1, v22
s_mul_i32 s50, s49, 4
s_add_u32 s51, s50, 0
v_xor_b32 v22, s51, v20
v_lshl_add_u32 v10, v22, 5, v21
s_add_u32 s51, s50, 1
v_xor_b32 v22, s51, v20
v_lshl_add_u32 v11, v22, 5, v21
s_add_u32 s51, s50, 2
v_xor_b32 v22, s51, v20
v_lshl_add_u32 v12, v22, 5, v21
s_add_u32 s51, s50, 3
v_xor_b32 v22, s51, v20
v_lshl_add_u32 v13, v22, 5, v21
v_mov_b64 v[128:129], 0
v_mov_b64 v[130:131], 0
v_mov_b64 v[132:133], 0
v_mov_b64 v[134:135], 0
v_mov_b64 v[136:137], 0
v_mov_b64 v[138:139], 0
v_mov_b64 v[140:141], 0
v_mov_b64 v[142:143], 0
v_mov_b64 v[144:145], 0
v_mov_b64 v[146:147], 0
v_mov_b64 v[148:149], 0
v_mov_b64 v[150:151], 0
v_mov_b64 v[152:153], 0
v_mov_b64 v[154:155], 0
v_mov_b64 v[156:157], 0
v_mov_b64 v[158:159], 0
v_mov_b64 v[160:161], 0
v_mov_b64 v[162:163], 0
v_mov_b64 v[164:165], 0
v_mov_b64 v[166:167], 0
v_mov_b64 v[168:169], 0
v_mov_b64 v[170:171], 0
v_mov_b64 v[172:173], 0
v_mov_b64 v[174:175], 0
v_mov_b64 v[176:177], 0
v_mov_b64 v[178:179], 0
v_mov_b64 v[180:181], 0
v_mov_b64 v[182:183], 0
v_mov_b64 v[184:185], 0
v_mov_b64 v[186:187], 0
v_mov_b64 v[188:189], 0
v_mov_b64 v[190:191], 0
s_mov_b32 s77, 0
s_waitcnt vmcnt(10)
s_barrier
ds_read_b64_tr_b16 v[56:57], v10 offset:0
ds_read_b64_tr_b16 v[58:59], v10 offset:1024
ds_read_b128 v[24:27], v8 offset:0
ds_read_b128 v[28:31], v8 offset:2048
ds_read_b128 v[32:35], v8 offset:4096
ds_read_b128 v[36:39], v8 offset:6144
ds_read_b64_tr_b16 v[60:61], v11 offset:0
ds_read_b64_tr_b16 v[62:63], v11 offset:1024
ds_read_b64_tr_b16 v[64:65], v12 offset:0
ds_read_b64_tr_b16 v[66:67], v12 offset:1024
ds_read_b64_tr_b16 v[68:69], v13 offset:0
ds_read_b64_tr_b16 v[70:71], v13 offset:1024
s_mov_b32 s66, 0
s_branch Lgn_65
.p2align 6
Lg_60:
s_waitcnt vmcnt(6) lgkmcnt(0)
s_barrier
Lgb_61:
v_mfma_f32_16x16x32_bf16 v[128:131], v[72:75], v[40:43], v[128:131]
ds_read_b64_tr_b16 v[56:57], v10 offset:0
ds_read_b64_tr_b16 v[58:59], v10 offset:1024
v_mfma_f32_16x16x32_bf16 v[132:135], v[72:75], v[44:47], v[132:135]
ds_read_b128 v[24:27], v8 offset:0
s_mov_b32 m0, s67
s_nop 0
buffer_load_dwordx4 v2, s[36:39], s64 offen offset:0  lds
v_mfma_f32_16x16x32_bf16 v[136:139], v[72:75], v[48:51], v[136:139]
ds_read_b128 v[28:31], v8 offset:2048
ds_read_b128 v[32:35], v8 offset:4096
v_mfma_f32_16x16x32_bf16 v[140:143], v[72:75], v[52:55], v[140:143]
ds_read_b128 v[36:39], v8 offset:6144
buffer_load_dwordx4 v3, s[36:39], s64 offen offset:1024  lds
v_mfma_f32_16x16x32_bf16 v[144:147], v[76:79], v[40:43], v[144:147]
ds_read_b64_tr_b16 v[60:61], v11 offset:0
ds_read_b64_tr_b16 v[62:63], v11 offset:1024
v_mfma_f32_16x16x32_bf16 v[148:151], v[76:79], v[44:47], v[148:151]
ds_read_b64_tr_b16 v[64:65], v12 offset:0
buffer_load_dwordx4 v4, s[36:39], s64 offen offset:2048  lds
v_mfma_f32_16x16x32_bf16 v[152:155], v[76:79], v[48:51], v[152:155]
ds_read_b64_tr_b16 v[66:67], v12 offset:1024
ds_read_b64_tr_b16 v[68:69], v13 offset:0
v_mfma_f32_16x16x32_bf16 v[156:159], v[76:79], v[52:55], v[156:159]
ds_read_b64_tr_b16 v[70:71], v13 offset:1024
buffer_load_dwordx4 v5, s[36:39], s64 offen offset:3072  lds
s_add_u32 s67, s67, s62
s_add_u32 s64, s64, s92
s_and_b32 s64, s64, 2047
v_mfma_f32_16x16x32_bf16 v[160:163], v[80:83], v[40:43], v[160:163]
s_add_u32 s66, s66, 1
s_cmp_eq_u32 s66, 16
v_mfma_f32_16x16x32_bf16 v[164:167], v[80:83], v[44:47], v[164:167]
v_mfma_f32_16x16x32_bf16 v[168:171], v[80:83], v[48:51], v[168:171]
v_mfma_f32_16x16x32_bf16 v[172:175], v[80:83], v[52:55], v[172:175]
v_mfma_f32_16x16x32_bf16 v[176:179], v[84:87], v[40:43], v[176:179]
v_mfma_f32_16x16x32_bf16 v[180:183], v[84:87], v[44:47], v[180:183]
v_mfma_f32_16x16x32_bf16 v[184:187], v[84:87], v[48:51], v[184:187]
v_mfma_f32_16x16x32_bf16 v[188:191], v[84:87], v[52:55], v[188:191]
s_cbranch_scc1 Lge_67
Lgn_65:
s_waitcnt lgkmcnt(0)
v_mfma_f32_16x16x32_bf16 v[128:131], v[56:59], v[24:27], v[128:131]
ds_read_b64_tr_b16 v[72:73], v10 offset:8192
ds_read_b64_tr_b16 v[74:75], v10 offset:9216
v_mfma_f32_16x16x32_bf16 v[132:135], v[56:59], v[28:31], v[132:135]
ds_read_b128 v[40:43], v9 offset:0
ds_read_b128 v[44:47], v9 offset:2048
v_mfma_f32_16x16x32_bf16 v[136:139], v[56:59], v[32:35], v[136:139]
ds_read_b128 v[48:51], v9 offset:4096
ds_read_b128 v[52:55], v9 offset:6144
v_mfma_f32_16x16x32_bf16 v[140:143], v[56:59], v[36:39], v[140:143]
s_mov_b32 m0, s68
s_nop 0
buffer_load_dwordx4 v6, s[40:43], s65 offen offset:0 lds
ds_read_b64_tr_b16 v[76:77], v11 offset:8192
v_mfma_f32_16x16x32_bf16 v[144:147], v[60:63], v[24:27], v[144:147]
ds_read_b64_tr_b16 v[78:79], v11 offset:9216
ds_read_b64_tr_b16 v[80:81], v12 offset:8192
v_mfma_f32_16x16x32_bf16 v[148:151], v[60:63], v[28:31], v[148:151]
ds_read_b64_tr_b16 v[82:83], v12 offset:9216
ds_read_b64_tr_b16 v[84:85], v13 offset:8192
v_mfma_f32_16x16x32_bf16 v[152:155], v[60:63], v[32:35], v[152:155]
ds_read_b64_tr_b16 v[86:87], v13 offset:9216
buffer_load_dwordx4 v7, s[40:43], s65 offen offset:1024 lds
s_add_u32 s68, s68, s63
s_add_u32 s65, s65, s93
s_and_b32 s65, s65, 8388607
v_mfma_f32_16x16x32_bf16 v[156:159], v[60:63], v[36:39], v[156:159]
s_add_u32 s69, s69, 1
s_cmp_eq_u32 s69, 3
s_cselect_b32 s69, 0, s69
s_mov_b32 s62, 32768
s_cselect_b32 s62, 0xffff0000, s62
s_mov_b32 s63, 16384
s_cselect_b32 s63, 0xffff8000, s63
v_add_u32 v8, s62, v8
v_mfma_f32_16x16x32_bf16 v[160:163], v[64:67], v[24:27], v[160:163]
v_add_u32 v9, s62, v9
v_add_u32 v10, s63, v10
v_mfma_f32_16x16x32_bf16 v[164:167], v[64:67], v[28:31], v[164:167]
v_add_u32 v11, s63, v11
v_add_u32 v12, s63, v12
v_mfma_f32_16x16x32_bf16 v[168:171], v[64:67], v[32:35], v[168:171]
v_add_u32 v13, s63, v13
v_mfma_f32_16x16x32_bf16 v[172:175], v[64:67], v[36:39], v[172:175]
v_mfma_f32_16x16x32_bf16 v[176:179], v[68:71], v[24:27], v[176:179]
v_mfma_f32_16x16x32_bf16 v[180:183], v[68:71], v[28:31], v[180:183]
v_mfma_f32_16x16x32_bf16 v[184:187], v[68:71], v[32:35], v[184:187]
v_mfma_f32_16x16x32_bf16 v[188:191], v[68:71], v[36:39], v[188:191]
s_cmp_eq_u32 s66, 13
s_cbranch_scc1 Lgs_63
Lgsb_64:
s_cmp_eq_u32 s77, 0
s_cbranch_scc1 Lg_60
s_branch Lgh_62
Lge_67:
s_mov_b32 s66, 0
s_cmp_ge_u32 s75, 32
s_cbranch_scc1 Lqs_68
s_mov_b32 s58, 0x3e0293ee
s_nop 7
v_pk_mul_f32 v[128:129], v[128:129], s[58:59] op_sel_hi:[1,0]
v_pk_mul_f32 v[130:131], v[130:131], s[58:59] op_sel_hi:[1,0]
v_pk_mul_f32 v[132:133], v[132:133], s[58:59] op_sel_hi:[1,0]
v_pk_mul_f32 v[134:135], v[134:135], s[58:59] op_sel_hi:[1,0]
v_pk_mul_f32 v[136:137], v[136:137], s[58:59] op_sel_hi:[1,0]
v_pk_mul_f32 v[138:139], v[138:139], s[58:59] op_sel_hi:[1,0]
v_pk_mul_f32 v[140:141], v[140:141], s[58:59] op_sel_hi:[1,0]
v_pk_mul_f32 v[142:143], v[142:143], s[58:59] op_sel_hi:[1,0]
v_pk_mul_f32 v[144:145], v[144:145], s[58:59] op_sel_hi:[1,0]
v_pk_mul_f32 v[146:147], v[146:147], s[58:59] op_sel_hi:[1,0]
v_pk_mul_f32 v[148:149], v[148:149], s[58:59] op_sel_hi:[1,0]
v_pk_mul_f32 v[150:151], v[150:151], s[58:59] op_sel_hi:[1,0]
v_pk_mul_f32 v[152:153], v[152:153], s[58:59] op_sel_hi:[1,0]
v_pk_mul_f32 v[154:155], v[154:155], s[58:59] op_sel_hi:[1,0]
v_pk_mul_f32 v[156:157], v[156:157], s[58:59] op_sel_hi:[1,0]
v_pk_mul_f32 v[158:159], v[158:159], s[58:59] op_sel_hi:[1,0]
v_pk_mul_f32 v[160:161], v[160:161], s[58:59] op_sel_hi:[1,0]
v_pk_mul_f32 v[162:163], v[162:163], s[58:59] op_sel_hi:[1,0]
v_pk_mul_f32 v[164:165], v[164:165], s[58:59] op_sel_hi:[1,0]
v_pk_mul_f32 v[166:167], v[166:167], s[58:59] op_sel_hi:[1,0]
v_pk_mul_f32 v[168:169], v[168:169], s[58:59] op_sel_hi:[1,0]
v_pk_mul_f32 v[170:171], v[170:171], s[58:59] op_sel_hi:[1,0]
v_pk_mul_f32 v[172:173], v[172:173], s[58:59] op_sel_hi:[1,0]
v_pk_mul_f32 v[174:175], v[174:175], s[58:59] op_sel_hi:[1,0]
v_pk_mul_f32 v[176:177], v[176:177], s[58:59] op_sel_hi:[1,0]
v_pk_mul_f32 v[178:179], v[178:179], s[58:59] op_sel_hi:[1,0]
v_pk_mul_f32 v[180:181], v[180:181], s[58:59] op_sel_hi:[1,0]
v_pk_mul_f32 v[182:183], v[182:183], s[58:59] op_sel_hi:[1,0]
v_pk_mul_f32 v[184:185], v[184:185], s[58:59] op_sel_hi:[1,0]
v_pk_mul_f32 v[186:187], v[186:187], s[58:59] op_sel_hi:[1,0]
v_pk_mul_f32 v[188:189], v[188:189], s[58:59] op_sel_hi:[1,0]
v_pk_mul_f32 v[190:191], v[190:191], s[58:59] op_sel_hi:[1,0]
Lqs_68:
s_lshr_b32 s58, s75, 5
s_lshl_b32 s58, s58, 24
s_mul_i32 s59, s74, 2097152
s_add_u32 s58, s58, s59
s_and_b32 s59, s75, 31
s_lshl_b32 s59, s59, 13
s_add_u32 s58, s58, s59
s_mov_b32 s44, s32
s_mov_b32 s45, s33
s_mov_b32 s46, 268435456
s_add_u32 s44, s44, s58
s_addc_u32 s45, s45, 0
s_sub_u32 s46, s46, s58
s_and_b32 s45, s45, 0xffff
s_mov_b32 s47, 0x20000
s_lshr_b32 s60, s34, 1
s_and_b32 s61, s34, 1
s_mul_i32 s58, s61, 2
s_lshr_b32 s59, s58, 2
s_lshl_b32 s59, s59, 13
s_and_b32 s58, s58, 3
s_lshl_b32 s58, s58, 10
s_add_u32 s58, s58, s59
s_mul_i32 s59, s60, 524288
s_add_u32 s58, s58, s59
v_and_b32 v92, 15, v0
v_lshlrev_b32 v92, 4, v92
v_bfe_u32 v93, v0, 4, 1
v_lshl_add_u32 v92, v93, 9, v92
v_lshrrev_b32 v93, 5, v0
v_lshl_add_u32 v92, v93, 8, v92
v_cvt_pk_bf16_f32 v96, v128, v129
v_cvt_pk_bf16_f32 v97, v130, v131
v_cvt_pk_bf16_f32 v98, v144, v145
v_cvt_pk_bf16_f32 v99, v146, v147
s_nop 0
v_permlane16_swap_b32 v96, v98
v_permlane16_swap_b32 v97, v99
buffer_store_dwordx4 v[96:99], v92, s[44:47], s58 offen offset:0 sc1
v_cvt_pk_bf16_f32 v100, v160, v161
v_cvt_pk_bf16_f32 v101, v162, v163
v_cvt_pk_bf16_f32 v102, v176, v177
v_cvt_pk_bf16_f32 v103, v178, v179
s_nop 0
v_permlane16_swap_b32 v100, v102
v_permlane16_swap_b32 v101, v103
buffer_store_dwordx4 v[100:103], v92, s[44:47], s58 offen offset:1024 sc1
v_cvt_pk_bf16_f32 v104, v132, v133
v_cvt_pk_bf16_f32 v105, v134, v135
v_cvt_pk_bf16_f32 v106, v148, v149
v_cvt_pk_bf16_f32 v107, v150, v151
s_nop 0
v_permlane16_swap_b32 v104, v106
v_permlane16_swap_b32 v105, v107
s_add_u32 s58, s58, 4096
buffer_store_dwordx4 v[104:107], v92, s[44:47], s58 offen offset:0 sc1
v_cvt_pk_bf16_f32 v108, v164, v165
v_cvt_pk_bf16_f32 v109, v166, v167
v_cvt_pk_bf16_f32 v110, v180, v181
v_cvt_pk_bf16_f32 v111, v182, v183
s_nop 0
v_permlane16_swap_b32 v108, v110
v_permlane16_swap_b32 v109, v111
buffer_store_dwordx4 v[108:111], v92, s[44:47], s58 offen offset:1024 sc1
v_cvt_pk_bf16_f32 v112, v136, v137
v_cvt_pk_bf16_f32 v113, v138, v139
v_cvt_pk_bf16_f32 v114, v152, v153
v_cvt_pk_bf16_f32 v115, v154, v155
s_nop 0
v_permlane16_swap_b32 v112, v114
v_permlane16_swap_b32 v113, v115
s_add_u32 s58, s58, 258048
buffer_store_dwordx4 v[112:115], v92, s[44:47], s58 offen offset:0 sc1
v_cvt_pk_bf16_f32 v116, v168, v169
v_cvt_pk_bf16_f32 v117, v170, v171
v_cvt_pk_bf16_f32 v118, v184, v185
v_cvt_pk_bf16_f32 v119, v186, v187
s_nop 0
v_permlane16_swap_b32 v116, v118
v_permlane16_swap_b32 v117, v119
buffer_store_dwordx4 v[116:119], v92, s[44:47], s58 offen offset:1024 sc1
v_cvt_pk_bf16_f32 v120, v140, v141
v_cvt_pk_bf16_f32 v121, v142, v143
v_cvt_pk_bf16_f32 v122, v156, v157
v_cvt_pk_bf16_f32 v123, v158, v159
s_nop 0
v_permlane16_swap_b32 v120, v122
v_permlane16_swap_b32 v121, v123
s_add_u32 s58, s58, 4096
buffer_store_dwordx4 v[120:123], v92, s[44:47], s58 offen offset:0 sc1
v_cvt_pk_bf16_f32 v124, v172, v173
v_cvt_pk_bf16_f32 v125, v174, v175
v_cvt_pk_bf16_f32 v126, v188, v189
v_cvt_pk_bf16_f32 v127, v190, v191
s_nop 0
v_permlane16_swap_b32 v124, v126
v_permlane16_swap_b32 v125, v127
buffer_store_dwordx4 v[124:127], v92, s[44:47], s58 offen offset:1024 sc1
v_mov_b64 v[128:129], 0
v_mov_b64 v[130:131], 0
v_mov_b64 v[132:133], 0
v_mov_b64 v[134:135], 0
v_mov_b64 v[136:137], 0
v_mov_b64 v[138:139], 0
v_mov_b64 v[140:141], 0
v_mov_b64 v[142:143], 0
v_mov_b64 v[144:145], 0
v_mov_b64 v[146:147], 0
v_mov_b64 v[148:149], 0
v_mov_b64 v[150:151], 0
v_mov_b64 v[152:153], 0
v_mov_b64 v[154:155], 0
v_mov_b64 v[156:157], 0
v_mov_b64 v[158:159], 0
v_mov_b64 v[160:161], 0
v_mov_b64 v[162:163], 0
v_mov_b64 v[164:165], 0
v_mov_b64 v[166:167], 0
v_mov_b64 v[168:169], 0
v_mov_b64 v[170:171], 0
v_mov_b64 v[172:173], 0
v_mov_b64 v[174:175], 0
v_mov_b64 v[176:177], 0
v_mov_b64 v[178:179], 0
v_mov_b64 v[180:181], 0
v_mov_b64 v[182:183], 0
v_mov_b64 v[184:185], 0
v_mov_b64 v[186:187], 0
v_mov_b64 v[188:189], 0
v_mov_b64 v[190:191], 0
s_mov_b32 s61, s74
s_mov_b32 s77, 1
s_cmp_eq_u32 s76, 1
s_cbranch_scc1 Lgn_65
s_branch Lgx_66
Lgs_63:
s_mov_b32 s74, s72
s_mov_b32 s75, s73
v_readlane_b32 s73, v1, s71
s_add_u32 s71, s71, 1
s_lshr_b32 s76, s73, 16
s_bfe_u32 s72, s73, 0x80008
s_and_b32 s73, s73, 255
s_mul_i32 s52, s72, 524288
s_mov_b32 s36, s14
s_mov_b32 s37, s15
s_mov_b32 s38, 4194304
s_add_u32 s36, s36, s52
s_addc_u32 s37, s37, 0
s_sub_u32 s38, s38, s52
s_and_b32 s37, s37, 0xffff
s_mov_b32 s39, 0x20000
s_lshr_b32 s53, s73, 5
s_and_b32 s54, s73, 31
s_cmp_eq_u32 s53, 1
s_cselect_b32 s56, s20, s18
s_cselect_b32 s57, s21, s19
s_cmp_eq_u32 s53, 2
s_cselect_b32 s56, s22, s56
s_cselect_b32 s57, s23, s57
s_lshl_b32 s52, s54, 8
s_mov_b32 s40, s56
s_mov_b32 s41, s57
s_mov_b32 s42, 8388608
s_add_u32 s40, s40, s52
s_addc_u32 s41, s41, 0
s_sub_u32 s42, s42, s52
s_and_b32 s41, s41, 0xffff
s_mov_b32 s43, 0x20000
s_cmp_eq_u32 s76, 1
s_cbranch_scc1 Lsw_69
s_mov_b32 s38, 0
s_mov_b32 s42, 0
Lsw_69:
s_sub_u32 s92, 0, s92
s_sub_u32 s93, 0, s93
s_add_u32 s64, s64, s92
s_and_b32 s64, s64, 2047
s_add_u32 s65, s65, s93
s_and_b32 s65, s65, 8388607
s_branch Lgsb_64
Lgh_62:
s_sub_u32 s77, s77, 1
s_cmp_eq_u32 s77, 0
s_cbranch_scc1 Lgst_70
s_waitcnt vmcnt(14) lgkmcnt(0)
s_barrier
s_branch Lgb_61
Lgst_70:
s_waitcnt vmcnt(2) lgkmcnt(0)
s_barrier
s_cmp_lg_u32 s34, 0
s_cbranch_scc1 Lsig_71
s_lshl_b32 s58, s61, 3
v_lshl_add_u32 v92, v0, 2, s58
v_mov_b32 v93, 1
s_mov_b64 exec, 3
global_atomic_add v92, v93, s[30:31] offset:128
s_mov_b64 exec, -1
Lsig_71:
s_branch Lgb_61
Lgx_66:
s_waitcnt vmcnt(0) lgkmcnt(0)
s_barrier
s_cmp_lg_u32 s34, 0
s_cbranch_scc1 Lsig_72
s_lshl_b32 s58, s61, 3
v_lshl_add_u32 v92, v0, 2, s58
v_mov_b32 v93, 1
s_mov_b64 exec, 3
global_atomic_add v92, v93, s[30:31] offset:128
s_mov_b64 exec, -1
Lsig_72:
s_branch Ldisp
Ljob2:
s_mul_i32 s52, s72, 524288
s_mov_b32 s36, s14
s_mov_b32 s37, s15
s_mov_b32 s38, 4194304
s_add_u32 s36, s36, s52
s_addc_u32 s37, s37, 0
s_sub_u32 s38, s38, s52
s_and_b32 s37, s37, 0xffff
s_mov_b32 s39, 0x20000
s_lshr_b32 s53, s73, 5
s_and_b32 s54, s73, 31
s_cmp_eq_u32 s53, 1
s_cselect_b32 s56, s20, s18
s_cselect_b32 s57, s21, s19
s_cmp_eq_u32 s53, 2
s_cselect_b32 s56, s22, s56
s_cselect_b32 s57, s23, s57
s_lshl_b32 s52, s54, 8
s_mov_b32 s40, s56
s_mov_b32 s41, s57
s_mov_b32 s42, 8388608
s_add_u32 s40, s40, s52
s_addc_u32 s41, s41, 0
s_sub_u32 s42, s42, s52
s_and_b32 s41, s41, 0xffff
s_mov_b32 s43, 0x20000
s_lshr_b32 s48, s34, 2
s_and_b32 s49, s34, 3
s_mul_i32 s50, s34, 32
v_lshrrev_b32 v20, 3, v0
v_add_u32 v20, s50, v20
v_lshrrev_b32 v21, 1, v20
v_xor_b32 v21, v21, v0
v_and_b32 v21, 7, v21
v_lshlrev_b32 v21, 4, v21
v_mul_u32_u24 v20, 2048, v20
v_add_u32 v2, v20, v21
v_xor_b32 v21, 64, v21
v_add_u32 v21, v20, v21
v_add_u32 v3, 15360, v21
v_add_u32 v4, 30720, v2
v_add_u32 v5, 46080, v21
s_lshl_b32 s50, s34, 3
s_add_u32 s50, s50, 0
v_lshrrev_b32 v20, 5, v0
v_add_u32 v20, s50, v20
v_and_b32 v21, 3, v20
v_lshlrev_b32 v21, 2, v21
v_bfe_u32 v22, v20, 3, 1
v_lshl_or_b32 v21, v22, 1, v21
v_and_b32 v22, 31, v0
v_xor_b32 v21, v21, v22
v_mul_u32_u24 v20, 8192, v20
v_lshl_add_u32 v20, v21, 4, v20
v_subrev_u32 v6, 0, v20
s_lshl_b32 s50, s34, 3
s_add_u32 s50, s50, 2
v_lshrrev_b32 v20, 5, v0
v_add_u32 v20, s50, v20
v_and_b32 v21, 3, v20
v_lshlrev_b32 v21, 2, v21
v_bfe_u32 v22, v20, 3, 1
v_lshl_or_b32 v21, v22, 1, v21
v_and_b32 v22, 31, v0
v_xor_b32 v21, v21, v22
v_mul_u32_u24 v20, 8192, v20
v_lshl_add_u32 v20, v21, 4, v20
v_subrev_u32 v7, 1024, v20
s_lshl_b32 s50, s34, 3
s_add_u32 s50, s50, 4
v_lshrrev_b32 v20, 5, v0
v_add_u32 v20, s50, v20
v_and_b32 v21, 3, v20
v_lshlrev_b32 v21, 2, v21
v_bfe_u32 v22, v20, 3, 1
v_lshl_or_b32 v21, v22, 1, v21
v_and_b32 v22, 31, v0
v_xor_b32 v21, v21, v22
v_mul_u32_u24 v20, 8192, v20
v_lshl_add_u32 v20, v21, 4, v20
v_subrev_u32 v8, 2048, v20
s_lshl_b32 s50, s34, 3
s_add_u32 s50, s50, 6
v_lshrrev_b32 v20, 5, v0
v_add_u32 v20, s50, v20
v_and_b32 v21, 3, v20
v_lshlrev_b32 v21, 2, v21
v_bfe_u32 v22, v20, 3, 1
v_lshl_or_b32 v21, v22, 1, v21
v_and_b32 v22, 31, v0
v_xor_b32 v21, v21, v22
v_mul_u32_u24 v20, 8192, v20
v_lshl_add_u32 v20, v21, 4, v20
v_subrev_u32 v9, 3072, v20
s_mul_i32 s67, s34, 4096
s_mul_i32 s68, s34, 4096
s_add_u32 s68, s68, 65536
s_mul_i32 s65, s35, 1
s_and_b32 s65, s65, 13
s_mul_i32 s64, s65, 128
s_mul_i32 s65, s65, 524288
s_mov_b32 s69, 0
Lpro_73:
s_add_u32 s69, s69, 1
s_cmp_eq_u32 s69, 2
s_cselect_b32 s69, 0, s69
s_mov_b32 s62, 32768
s_cselect_b32 s62, 0xffff8000, s62
s_mov_b32 s63, 32768
s_cselect_b32 s63, 0xffff8000, s63
s_mov_b32 m0, s67
s_nop 0
buffer_load_dwordx4 v2, s[36:39], s64 offen offset:0  lds
buffer_load_dwordx4 v3, s[36:39], s64 offen offset:1024  lds
buffer_load_dwordx4 v4, s[36:39], s64 offen offset:2048  lds
buffer_load_dwordx4 v5, s[36:39], s64 offen offset:3072  lds
s_add_u32 s64, s64, 128
s_add_u32 s67, s67, s62
s_bitset0_b32 s64, 11
s_cmp_eq_u32 s69, 0
s_cbranch_scc1 Lprox_74
s_mov_b32 m0, s68
s_nop 0
buffer_load_dwordx4 v6, s[40:43], s65 offen offset:0 lds
buffer_load_dwordx4 v7, s[40:43], s65 offen offset:1024 lds
buffer_load_dwordx4 v8, s[40:43], s65 offen offset:2048 lds
buffer_load_dwordx4 v9, s[40:43], s65 offen offset:3072 lds
s_add_u32 s65, s65, 524288
s_add_u32 s68, s68, s63
s_bitset0_b32 s65, 23
s_branch Lpro_73
Lprox_74:
s_lshr_b32 s48, s34, 2
s_and_b32 s49, s34, 3
s_mul_i32 s50, s48, 16384
v_and_b32 v20, 15, v0
v_bfe_u32 v21, v0, 1, 3
v_lshrrev_b32 v22, 4, v0
v_xor_b32 v21, v21, v22
v_lshlrev_b32 v21, 4, v21
v_lshlrev_b32 v20, 7, v20
v_add_u32 v20, s50, v20
v_xor_b32 v22, 0, v21
v_add_u32 v10, v20, v22
v_xor_b32 v22, 64, v21
v_add_u32 v11, v20, v22
v_bfe_u32 v20, v0, 2, 2
v_lshrrev_b32 v21, 4, v0
v_lshl_add_u32 v21, v21, 3, v20
v_mul_u32_u24 v21, 512, v21
v_and_b32 v22, 3, v0
v_lshl_add_u32 v21, v22, 3, v21
v_add_u32 v21, 65536, v21
v_bfe_u32 v22, v0, 4, 1
v_lshl_or_b32 v20, v20, 1, v22
s_mul_i32 s50, s49, 4
s_add_u32 s51, s50, 0
v_xor_b32 v22, s51, v20
v_lshl_add_u32 v12, v22, 5, v21
s_add_u32 s51, s50, 1
v_xor_b32 v22, s51, v20
v_lshl_add_u32 v13, v22, 5, v21
s_add_u32 s51, s50, 2
v_xor_b32 v22, s51, v20
v_lshl_add_u32 v14, v22, 5, v21
s_add_u32 s51, s50, 3
v_xor_b32 v22, s51, v20
v_lshl_add_u32 v15, v22, 5, v21
v_mov_b64 v[128:129], 0
v_mov_b64 v[130:131], 0
v_mov_b64 v[132:133], 0
v_mov_b64 v[134:135], 0
v_mov_b64 v[136:137], 0
v_mov_b64 v[138:139], 0
v_mov_b64 v[140:141], 0
v_mov_b64 v[142:143], 0
v_mov_b64 v[144:145], 0
v_mov_b64 v[146:147], 0
v_mov_b64 v[148:149], 0
v_mov_b64 v[150:151], 0
v_mov_b64 v[152:153], 0
v_mov_b64 v[154:155], 0
v_mov_b64 v[156:157], 0
v_mov_b64 v[158:159], 0
v_mov_b64 v[160:161], 0
v_mov_b64 v[162:163], 0
v_mov_b64 v[164:165], 0
v_mov_b64 v[166:167], 0
v_mov_b64 v[168:169], 0
v_mov_b64 v[170:171], 0
v_mov_b64 v[172:173], 0
v_mov_b64 v[174:175], 0
v_mov_b64 v[176:177], 0
v_mov_b64 v[178:179], 0
v_mov_b64 v[180:181], 0
v_mov_b64 v[182:183], 0
v_mov_b64 v[184:185], 0
v_mov_b64 v[186:187], 0
v_mov_b64 v[188:189], 0
v_mov_b64 v[190:191], 0
v_mov_b64 v[192:193], 0
v_mov_b64 v[194:195], 0
v_mov_b64 v[196:197], 0
v_mov_b64 v[198:199], 0
v_mov_b64 v[200:201], 0
v_mov_b64 v[202:203], 0
v_mov_b64 v[204:205], 0
v_mov_b64 v[206:207], 0
v_mov_b64 v[208:209], 0
v_mov_b64 v[210:211], 0
v_mov_b64 v[212:213], 0
v_mov_b64 v[214:215], 0
v_mov_b64 v[216:217], 0
v_mov_b64 v[218:219], 0
v_mov_b64 v[220:221], 0
v_mov_b64 v[222:223], 0
v_mov_b64 v[224:225], 0
v_mov_b64 v[226:227], 0
v_mov_b64 v[228:229], 0
v_mov_b64 v[230:231], 0
v_mov_b64 v[232:233], 0
v_mov_b64 v[234:235], 0
v_mov_b64 v[236:237], 0
v_mov_b64 v[238:239], 0
v_mov_b64 v[240:241], 0
v_mov_b64 v[242:243], 0
v_mov_b64 v[244:245], 0
v_mov_b64 v[246:247], 0
v_mov_b64 v[248:249], 0
v_mov_b64 v[250:251], 0
v_mov_b64 v[252:253], 0
v_mov_b64 v[254:255], 0
s_mov_b32 s77, 0
s_waitcnt vmcnt(4)
s_barrier
ds_read_b64_tr_b16 v[56:57], v12 offset:0
ds_read_b64_tr_b16 v[58:59], v12 offset:2048
ds_read_b128 v[24:27], v10 offset:0
ds_read_b128 v[28:31], v10 offset:2048
ds_read_b128 v[32:35], v10 offset:4096
ds_read_b128 v[36:39], v10 offset:6144
ds_read_b64_tr_b16 v[60:61], v13 offset:0
ds_read_b64_tr_b16 v[62:63], v13 offset:2048
ds_read_b64_tr_b16 v[64:65], v14 offset:0
ds_read_b64_tr_b16 v[66:67], v14 offset:2048
ds_read_b64_tr_b16 v[68:69], v15 offset:0
ds_read_b64_tr_b16 v[70:71], v15 offset:2048
s_mov_b32 s66, 0
s_branch Lgn_80
.p2align 6
Lg_75:
s_waitcnt vmcnt(0) lgkmcnt(0)
s_barrier
Lgb_76:
v_mfma_f32_16x16x32_bf16 v[144:147], v[72:75], v[40:43], v[144:147]
ds_read_b64_tr_b16 v[56:57], v12 offset:0
ds_read_b64_tr_b16 v[58:59], v12 offset:2048
v_mfma_f32_16x16x32_bf16 v[148:151], v[72:75], v[44:47], v[148:151]
ds_read_b128 v[24:27], v10 offset:0
s_mov_b32 m0, s67
s_nop 0
buffer_load_dwordx4 v2, s[36:39], s64 offen offset:0  lds
v_mfma_f32_16x16x32_bf16 v[152:155], v[72:75], v[48:51], v[152:155]
ds_read_b128 v[28:31], v10 offset:2048
ds_read_b128 v[32:35], v10 offset:4096
v_mfma_f32_16x16x32_bf16 v[156:159], v[72:75], v[52:55], v[156:159]
ds_read_b128 v[36:39], v10 offset:6144
buffer_load_dwordx4 v3, s[36:39], s64 offen offset:1024  lds
v_mfma_f32_16x16x32_bf16 v[176:179], v[76:79], v[40:43], v[176:179]
ds_read_b64_tr_b16 v[60:61], v13 offset:0
ds_read_b64_tr_b16 v[62:63], v13 offset:2048
v_mfma_f32_16x16x32_bf16 v[180:183], v[76:79], v[44:47], v[180:183]
ds_read_b64_tr_b16 v[64:65], v14 offset:0
buffer_load_dwordx4 v4, s[36:39], s64 offen offset:2048  lds
v_mfma_f32_16x16x32_bf16 v[184:187], v[76:79], v[48:51], v[184:187]
ds_read_b64_tr_b16 v[66:67], v14 offset:2048
ds_read_b64_tr_b16 v[68:69], v15 offset:0
v_mfma_f32_16x16x32_bf16 v[188:191], v[76:79], v[52:55], v[188:191]
ds_read_b64_tr_b16 v[70:71], v15 offset:2048
buffer_load_dwordx4 v5, s[36:39], s64 offen offset:3072  lds
s_add_u32 s64, s64, 128
s_add_u32 s67, s67, s62
s_bitset0_b32 s64, 11
v_mfma_f32_16x16x32_bf16 v[208:211], v[80:83], v[40:43], v[208:211]
s_add_u32 s66, s66, 1
s_cmp_eq_u32 s66, 16
v_mfma_f32_16x16x32_bf16 v[212:215], v[80:83], v[44:47], v[212:215]
v_mfma_f32_16x16x32_bf16 v[216:219], v[80:83], v[48:51], v[216:219]
v_mfma_f32_16x16x32_bf16 v[220:223], v[80:83], v[52:55], v[220:223]
v_mfma_f32_16x16x32_bf16 v[240:243], v[84:87], v[40:43], v[240:243]
v_mfma_f32_16x16x32_bf16 v[244:247], v[84:87], v[44:47], v[244:247]
v_mfma_f32_16x16x32_bf16 v[248:251], v[84:87], v[48:51], v[248:251]
v_mfma_f32_16x16x32_bf16 v[252:255], v[84:87], v[52:55], v[252:255]
s_cbranch_scc1 Lge_82
Lgn_80:
s_waitcnt lgkmcnt(0)
v_mfma_f32_16x16x32_bf16 v[128:131], v[56:59], v[24:27], v[128:131]
ds_read_b128 v[40:43], v10 offset:8192
v_mfma_f32_16x16x32_bf16 v[132:135], v[56:59], v[28:31], v[132:135]
s_mov_b32 m0, s68
s_nop 0
buffer_load_dwordx4 v6, s[40:43], s65 offen offset:0 lds
v_mfma_f32_16x16x32_bf16 v[136:139], v[56:59], v[32:35], v[136:139]
ds_read_b128 v[44:47], v10 offset:10240
v_mfma_f32_16x16x32_bf16 v[140:143], v[56:59], v[36:39], v[140:143]
buffer_load_dwordx4 v7, s[40:43], s65 offen offset:1024 lds
v_mfma_f32_16x16x32_bf16 v[160:163], v[60:63], v[24:27], v[160:163]
ds_read_b128 v[48:51], v10 offset:12288
v_mfma_f32_16x16x32_bf16 v[164:167], v[60:63], v[28:31], v[164:167]
buffer_load_dwordx4 v8, s[40:43], s65 offen offset:2048 lds
v_mfma_f32_16x16x32_bf16 v[168:171], v[60:63], v[32:35], v[168:171]
ds_read_b128 v[52:55], v10 offset:14336
v_mfma_f32_16x16x32_bf16 v[172:175], v[60:63], v[36:39], v[172:175]
buffer_load_dwordx4 v9, s[40:43], s65 offen offset:3072 lds
s_add_u32 s65, s65, 524288
s_add_u32 s68, s68, s63
s_bitset0_b32 s65, 23
v_mfma_f32_16x16x32_bf16 v[192:195], v[64:67], v[24:27], v[192:195]
v_mfma_f32_16x16x32_bf16 v[196:199], v[64:67], v[28:31], v[196:199]
v_mfma_f32_16x16x32_bf16 v[200:203], v[64:67], v[32:35], v[200:203]
v_mfma_f32_16x16x32_bf16 v[204:207], v[64:67], v[36:39], v[204:207]
v_mfma_f32_16x16x32_bf16 v[224:227], v[68:71], v[24:27], v[224:227]
v_mfma_f32_16x16x32_bf16 v[228:231], v[68:71], v[28:31], v[228:231]
v_mfma_f32_16x16x32_bf16 v[232:235], v[68:71], v[32:35], v[232:235]
v_mfma_f32_16x16x32_bf16 v[236:239], v[68:71], v[36:39], v[236:239]
s_waitcnt lgkmcnt(0)
v_mfma_f32_16x16x32_bf16 v[144:147], v[56:59], v[40:43], v[144:147]
ds_read_b64_tr_b16 v[72:73], v12 offset:16384
v_mfma_f32_16x16x32_bf16 v[148:151], v[56:59], v[44:47], v[148:151]
ds_read_b64_tr_b16 v[74:75], v12 offset:18432
v_mfma_f32_16x16x32_bf16 v[152:155], v[56:59], v[48:51], v[152:155]
ds_read_b128 v[24:27], v11 offset:0
v_mfma_f32_16x16x32_bf16 v[156:159], v[56:59], v[52:55], v[156:159]
ds_read_b128 v[28:31], v11 offset:2048
v_mfma_f32_16x16x32_bf16 v[176:179], v[60:63], v[40:43], v[176:179]
ds_read_b128 v[32:35], v11 offset:4096
v_mfma_f32_16x16x32_bf16 v[180:183], v[60:63], v[44:47], v[180:183]
ds_read_b128 v[36:39], v11 offset:6144
v_mfma_f32_16x16x32_bf16 v[184:187], v[60:63], v[48:51], v[184:187]
ds_read_b64_tr_b16 v[76:77], v13 offset:16384
v_mfma_f32_16x16x32_bf16 v[188:191], v[60:63], v[52:55], v[188:191]
ds_read_b64_tr_b16 v[78:79], v13 offset:18432
v_mfma_f32_16x16x32_bf16 v[208:211], v[64:67], v[40:43], v[208:211]
ds_read_b64_tr_b16 v[80:81], v14 offset:16384
v_mfma_f32_16x16x32_bf16 v[212:215], v[64:67], v[44:47], v[212:215]
ds_read_b64_tr_b16 v[82:83], v14 offset:18432
v_mfma_f32_16x16x32_bf16 v[216:219], v[64:67], v[48:51], v[216:219]
ds_read_b64_tr_b16 v[84:85], v15 offset:16384
v_mfma_f32_16x16x32_bf16 v[220:223], v[64:67], v[52:55], v[220:223]
ds_read_b64_tr_b16 v[86:87], v15 offset:18432
v_mfma_f32_16x16x32_bf16 v[240:243], v[68:71], v[40:43], v[240:243]
v_mfma_f32_16x16x32_bf16 v[244:247], v[68:71], v[44:47], v[244:247]
v_mfma_f32_16x16x32_bf16 v[248:251], v[68:71], v[48:51], v[248:251]
v_mfma_f32_16x16x32_bf16 v[252:255], v[68:71], v[52:55], v[252:255]
s_waitcnt lgkmcnt(0)
v_mfma_f32_16x16x32_bf16 v[128:131], v[72:75], v[24:27], v[128:131]
ds_read_b128 v[40:43], v11 offset:8192
v_mfma_f32_16x16x32_bf16 v[132:135], v[72:75], v[28:31], v[132:135]
ds_read_b128 v[44:47], v11 offset:10240
v_mfma_f32_16x16x32_bf16 v[136:139], v[72:75], v[32:35], v[136:139]
ds_read_b128 v[48:51], v11 offset:12288
v_mfma_f32_16x16x32_bf16 v[140:143], v[72:75], v[36:39], v[140:143]
ds_read_b128 v[52:55], v11 offset:14336
v_mfma_f32_16x16x32_bf16 v[160:163], v[76:79], v[24:27], v[160:163]
s_add_u32 s69, s69, 1
s_cmp_eq_u32 s69, 2
s_cselect_b32 s69, 0, s69
s_mov_b32 s62, 32768
s_cselect_b32 s62, 0xffff8000, s62
s_mov_b32 s63, 32768
s_cselect_b32 s63, 0xffff8000, s63
v_mfma_f32_16x16x32_bf16 v[164:167], v[76:79], v[28:31], v[164:167]
v_add_u32 v10, s62, v10
v_mfma_f32_16x16x32_bf16 v[168:171], v[76:79], v[32:35], v[168:171]
v_add_u32 v11, s62, v11
v_mfma_f32_16x16x32_bf16 v[172:175], v[76:79], v[36:39], v[172:175]
v_add_u32 v12, s63, v12
v_mfma_f32_16x16x32_bf16 v[192:195], v[80:83], v[24:27], v[192:195]
v_add_u32 v13, s63, v13
v_mfma_f32_16x16x32_bf16 v[196:199], v[80:83], v[28:31], v[196:199]
v_add_u32 v14, s63, v14
v_mfma_f32_16x16x32_bf16 v[200:203], v[80:83], v[32:35], v[200:203]
v_add_u32 v15, s63, v15
v_mfma_f32_16x16x32_bf16 v[204:207], v[80:83], v[36:39], v[204:207]
v_mfma_f32_16x16x32_bf16 v[224:227], v[84:87], v[24:27], v[224:227]
v_mfma_f32_16x16x32_bf16 v[228:231], v[84:87], v[28:31], v[228:231]
v_mfma_f32_16x16x32_bf16 v[232:235], v[84:87], v[32:35], v[232:235]
v_mfma_f32_16x16x32_bf16 v[236:239], v[84:87], v[36:39], v[236:239]
s_cmp_eq_u32 s66, 14
s_cbranch_scc1 Lgs_78
Lgsb_79:
s_cmp_eq_u32 s77, 0
s_cbranch_scc1 Lg_75
s_branch Lgh_77
Lge_82:
s_mov_b32 s66, 0
s_cmp_ge_u32 s75, 32
s_cbranch_scc1 Lqs_83
s_mov_b32 s58, 0x3e0293ee
s_nop 7
v_pk_mul_f32 v[128:129], v[128:129], s[58:59] op_sel_hi:[1,0]
v_pk_mul_f32 v[130:131], v[130:131], s[58:59] op_sel_hi:[1,0]
v_pk_mul_f32 v[132:133], v[132:133], s[58:59] op_sel_hi:[1,0]
v_pk_mul_f32 v[134:135], v[134:135], s[58:59] op_sel_hi:[1,0]
v_pk_mul_f32 v[136:137], v[136:137], s[58:59] op_sel_hi:[1,0]
v_pk_mul_f32 v[138:139], v[138:139], s[58:59] op_sel_hi:[1,0]
v_pk_mul_f32 v[140:141], v[140:141], s[58:59] op_sel_hi:[1,0]
v_pk_mul_f32 v[142:143], v[142:143], s[58:59] op_sel_hi:[1,0]
v_pk_mul_f32 v[144:145], v[144:145], s[58:59] op_sel_hi:[1,0]
v_pk_mul_f32 v[146:147], v[146:147], s[58:59] op_sel_hi:[1,0]
v_pk_mul_f32 v[148:149], v[148:149], s[58:59] op_sel_hi:[1,0]
v_pk_mul_f32 v[150:151], v[150:151], s[58:59] op_sel_hi:[1,0]
v_pk_mul_f32 v[152:153], v[152:153], s[58:59] op_sel_hi:[1,0]
v_pk_mul_f32 v[154:155], v[154:155], s[58:59] op_sel_hi:[1,0]
v_pk_mul_f32 v[156:157], v[156:157], s[58:59] op_sel_hi:[1,0]
v_pk_mul_f32 v[158:159], v[158:159], s[58:59] op_sel_hi:[1,0]
v_pk_mul_f32 v[160:161], v[160:161], s[58:59] op_sel_hi:[1,0]
v_pk_mul_f32 v[162:163], v[162:163], s[58:59] op_sel_hi:[1,0]
v_pk_mul_f32 v[164:165], v[164:165], s[58:59] op_sel_hi:[1,0]
v_pk_mul_f32 v[166:167], v[166:167], s[58:59] op_sel_hi:[1,0]
v_pk_mul_f32 v[168:169], v[168:169], s[58:59] op_sel_hi:[1,0]
v_pk_mul_f32 v[170:171], v[170:171], s[58:59] op_sel_hi:[1,0]
v_pk_mul_f32 v[172:173], v[172:173], s[58:59] op_sel_hi:[1,0]
v_pk_mul_f32 v[174:175], v[174:175], s[58:59] op_sel_hi:[1,0]
v_pk_mul_f32 v[176:177], v[176:177], s[58:59] op_sel_hi:[1,0]
v_pk_mul_f32 v[178:179], v[178:179], s[58:59] op_sel_hi:[1,0]
v_pk_mul_f32 v[180:181], v[180:181], s[58:59] op_sel_hi:[1,0]
v_pk_mul_f32 v[182:183], v[182:183], s[58:59] op_sel_hi:[1,0]
v_pk_mul_f32 v[184:185], v[184:185], s[58:59] op_sel_hi:[1,0]
v_pk_mul_f32 v[186:187], v[186:187], s[58:59] op_sel_hi:[1,0]
v_pk_mul_f32 v[188:189], v[188:189], s[58:59] op_sel_hi:[1,0]
v_pk_mul_f32 v[190:191], v[190:191], s[58:59] op_sel_hi:[1,0]
v_pk_mul_f32 v[192:193], v[192:193], s[58:59] op_sel_hi:[1,0]
v_pk_mul_f32 v[194:195], v[194:195], s[58:59] op_sel_hi:[1,0]
v_pk_mul_f32 v[196:197], v[196:197], s[58:59] op_sel_hi:[1,0]
v_pk_mul_f32 v[198:199], v[198:199], s[58:59] op_sel_hi:[1,0]
v_pk_mul_f32 v[200:201], v[200:201], s[58:59] op_sel_hi:[1,0]
v_pk_mul_f32 v[202:203], v[202:203], s[58:59] op_sel_hi:[1,0]
v_pk_mul_f32 v[204:205], v[204:205], s[58:59] op_sel_hi:[1,0]
v_pk_mul_f32 v[206:207], v[206:207], s[58:59] op_sel_hi:[1,0]
v_pk_mul_f32 v[208:209], v[208:209], s[58:59] op_sel_hi:[1,0]
v_pk_mul_f32 v[210:211], v[210:211], s[58:59] op_sel_hi:[1,0]
v_pk_mul_f32 v[212:213], v[212:213], s[58:59] op_sel_hi:[1,0]
v_pk_mul_f32 v[214:215], v[214:215], s[58:59] op_sel_hi:[1,0]
v_pk_mul_f32 v[216:217], v[216:217], s[58:59] op_sel_hi:[1,0]
v_pk_mul_f32 v[218:219], v[218:219], s[58:59] op_sel_hi:[1,0]
v_pk_mul_f32 v[220:221], v[220:221], s[58:59] op_sel_hi:[1,0]
v_pk_mul_f32 v[222:223], v[222:223], s[58:59] op_sel_hi:[1,0]
v_pk_mul_f32 v[224:225], v[224:225], s[58:59] op_sel_hi:[1,0]
v_pk_mul_f32 v[226:227], v[226:227], s[58:59] op_sel_hi:[1,0]
v_pk_mul_f32 v[228:229], v[228:229], s[58:59] op_sel_hi:[1,0]
v_pk_mul_f32 v[230:231], v[230:231], s[58:59] op_sel_hi:[1,0]
v_pk_mul_f32 v[232:233], v[232:233], s[58:59] op_sel_hi:[1,0]
v_pk_mul_f32 v[234:235], v[234:235], s[58:59] op_sel_hi:[1,0]
v_pk_mul_f32 v[236:237], v[236:237], s[58:59] op_sel_hi:[1,0]
v_pk_mul_f32 v[238:239], v[238:239], s[58:59] op_sel_hi:[1,0]
v_pk_mul_f32 v[240:241], v[240:241], s[58:59] op_sel_hi:[1,0]
v_pk_mul_f32 v[242:243], v[242:243], s[58:59] op_sel_hi:[1,0]
v_pk_mul_f32 v[244:245], v[244:245], s[58:59] op_sel_hi:[1,0]
v_pk_mul_f32 v[246:247], v[246:247], s[58:59] op_sel_hi:[1,0]
v_pk_mul_f32 v[248:249], v[248:249], s[58:59] op_sel_hi:[1,0]
v_pk_mul_f32 v[250:251], v[250:251], s[58:59] op_sel_hi:[1,0]
v_pk_mul_f32 v[252:253], v[252:253], s[58:59] op_sel_hi:[1,0]
v_pk_mul_f32 v[254:255], v[254:255], s[58:59] op_sel_hi:[1,0]
Lqs_83:
s_lshr_b32 s58, s75, 5
s_lshl_b32 s58, s58, 24
s_mul_i32 s59, s74, 2097152
s_add_u32 s58, s58, s59
s_and_b32 s59, s75, 31
s_lshl_b32 s59, s59, 13
s_add_u32 s58, s58, s59
s_mov_b32 s44, s32
s_mov_b32 s45, s33
s_mov_b32 s46, 268435456
s_add_u32 s44, s44, s58
s_addc_u32 s45, s45, 0
s_sub_u32 s46, s46, s58
s_and_b32 s45, s45, 0xffff
s_mov_b32 s47, 0x20000
s_lshr_b32 s60, s34, 2
s_and_b32 s61, s34, 3
s_mul_i32 s58, s61, 2
s_lshr_b32 s59, s58, 2
s_lshl_b32 s59, s59, 13
s_and_b32 s58, s58, 3
s_lshl_b32 s58, s58, 10
s_add_u32 s58, s58, s59
s_mul_i32 s59, s60, 1048576
s_add_u32 s58, s58, s59
v_and_b32 v92, 15, v0
v_lshlrev_b32 v92, 4, v92
v_bfe_u32 v93, v0, 4, 1
v_lshl_add_u32 v92, v93, 9, v92
v_lshrrev_b32 v93, 5, v0
v_lshl_add_u32 v92, v93, 8, v92
v_cvt_pk_bf16_f32 v96, v128, v129
v_cvt_pk_bf16_f32 v97, v130, v131
v_cvt_pk_bf16_f32 v98, v160, v161
v_cvt_pk_bf16_f32 v99, v162, v163
s_nop 0
v_permlane16_swap_b32 v96, v98
v_permlane16_swap_b32 v97, v99
buffer_store_dwordx4 v[96:99], v92, s[44:47], s58 offen offset:0 sc1
v_cvt_pk_bf16_f32 v100, v192, v193
v_cvt_pk_bf16_f32 v101, v194, v195
v_cvt_pk_bf16_f32 v102, v224, v225
v_cvt_pk_bf16_f32 v103, v226, v227
s_nop 0
v_permlane16_swap_b32 v100, v102
v_permlane16_swap_b32 v101, v103
buffer_store_dwordx4 v[100:103], v92, s[44:47], s58 offen offset:1024 sc1
v_cvt_pk_bf16_f32 v104, v132, v133
v_cvt_pk_bf16_f32 v105, v134, v135
v_cvt_pk_bf16_f32 v106, v164, v165
v_cvt_pk_bf16_f32 v107, v166, v167
s_nop 0
v_permlane16_swap_b32 v104, v106
v_permlane16_swap_b32 v105, v107
s_add_u32 s58, s58, 4096
buffer_store_dwordx4 v[104:107], v92, s[44:47], s58 offen offset:0 sc1
v_cvt_pk_bf16_f32 v108, v196, v197
v_cvt_pk_bf16_f32 v109, v198, v199
v_cvt_pk_bf16_f32 v110, v228, v229
v_cvt_pk_bf16_f32 v111, v230, v231
s_nop 0
v_permlane16_swap_b32 v108, v110
v_permlane16_swap_b32 v109, v111
buffer_store_dwordx4 v[108:111], v92, s[44:47], s58 offen offset:1024 sc1
v_cvt_pk_bf16_f32 v112, v136, v137
v_cvt_pk_bf16_f32 v113, v138, v139
v_cvt_pk_bf16_f32 v114, v168, v169
v_cvt_pk_bf16_f32 v115, v170, v171
s_nop 0
v_permlane16_swap_b32 v112, v114
v_permlane16_swap_b32 v113, v115
s_add_u32 s58, s58, 258048
buffer_store_dwordx4 v[112:115], v92, s[44:47], s58 offen offset:0 sc1
v_cvt_pk_bf16_f32 v116, v200, v201
v_cvt_pk_bf16_f32 v117, v202, v203
v_cvt_pk_bf16_f32 v118, v232, v233
v_cvt_pk_bf16_f32 v119, v234, v235
s_nop 0
v_permlane16_swap_b32 v116, v118
v_permlane16_swap_b32 v117, v119
buffer_store_dwordx4 v[116:119], v92, s[44:47], s58 offen offset:1024 sc1
v_cvt_pk_bf16_f32 v120, v140, v141
v_cvt_pk_bf16_f32 v121, v142, v143
v_cvt_pk_bf16_f32 v122, v172, v173
v_cvt_pk_bf16_f32 v123, v174, v175
s_nop 0
v_permlane16_swap_b32 v120, v122
v_permlane16_swap_b32 v121, v123
s_add_u32 s58, s58, 4096
buffer_store_dwordx4 v[120:123], v92, s[44:47], s58 offen offset:0 sc1
v_cvt_pk_bf16_f32 v124, v204, v205
v_cvt_pk_bf16_f32 v125, v206, v207
v_cvt_pk_bf16_f32 v126, v236, v237
v_cvt_pk_bf16_f32 v127, v238, v239
s_nop 0
v_permlane16_swap_b32 v124, v126
v_permlane16_swap_b32 v125, v127
buffer_store_dwordx4 v[124:127], v92, s[44:47], s58 offen offset:1024 sc1
v_cvt_pk_bf16_f32 v96, v144, v145
v_cvt_pk_bf16_f32 v97, v146, v147
v_cvt_pk_bf16_f32 v98, v176, v177
v_cvt_pk_bf16_f32 v99, v178, v179
s_nop 0
v_permlane16_swap_b32 v96, v98
v_permlane16_swap_b32 v97, v99
s_add_u32 s58, s58, 258048
buffer_store_dwordx4 v[96:99], v92, s[44:47], s58 offen offset:0 sc1
v_cvt_pk_bf16_f32 v100, v208, v209
v_cvt_pk_bf16_f32 v101, v210, v211
v_cvt_pk_bf16_f32 v102, v240, v241
v_cvt_pk_bf16_f32 v103, v242, v243
s_nop 0
v_permlane16_swap_b32 v100, v102
v_permlane16_swap_b32 v101, v103
buffer_store_dwordx4 v[100:103], v92, s[44:47], s58 offen offset:1024 sc1
v_cvt_pk_bf16_f32 v104, v148, v149
v_cvt_pk_bf16_f32 v105, v150, v151
v_cvt_pk_bf16_f32 v106, v180, v181
v_cvt_pk_bf16_f32 v107, v182, v183
s_nop 0
v_permlane16_swap_b32 v104, v106
v_permlane16_swap_b32 v105, v107
s_add_u32 s58, s58, 4096
buffer_store_dwordx4 v[104:107], v92, s[44:47], s58 offen offset:0 sc1
v_cvt_pk_bf16_f32 v108, v212, v213
v_cvt_pk_bf16_f32 v109, v214, v215
v_cvt_pk_bf16_f32 v110, v244, v245
v_cvt_pk_bf16_f32 v111, v246, v247
s_nop 0
v_permlane16_swap_b32 v108, v110
v_permlane16_swap_b32 v109, v111
buffer_store_dwordx4 v[108:111], v92, s[44:47], s58 offen offset:1024 sc1
v_cvt_pk_bf16_f32 v112, v152, v153
v_cvt_pk_bf16_f32 v113, v154, v155
v_cvt_pk_bf16_f32 v114, v184, v185
v_cvt_pk_bf16_f32 v115, v186, v187
s_nop 0
v_permlane16_swap_b32 v112, v114
v_permlane16_swap_b32 v113, v115
s_add_u32 s58, s58, 258048
buffer_store_dwordx4 v[112:115], v92, s[44:47], s58 offen offset:0 sc1
v_cvt_pk_bf16_f32 v116, v216, v217
v_cvt_pk_bf16_f32 v117, v218, v219
v_cvt_pk_bf16_f32 v118, v248, v249
v_cvt_pk_bf16_f32 v119, v250, v251
s_nop 0
v_permlane16_swap_b32 v116, v118
v_permlane16_swap_b32 v117, v119
buffer_store_dwordx4 v[116:119], v92, s[44:47], s58 offen offset:1024 sc1
v_cvt_pk_bf16_f32 v120, v156, v157
v_cvt_pk_bf16_f32 v121, v158, v159
v_cvt_pk_bf16_f32 v122, v188, v189
v_cvt_pk_bf16_f32 v123, v190, v191
s_nop 0
v_permlane16_swap_b32 v120, v122
v_permlane16_swap_b32 v121, v123
s_add_u32 s58, s58, 4096
buffer_store_dwordx4 v[120:123], v92, s[44:47], s58 offen offset:0 sc1
v_cvt_pk_bf16_f32 v124, v220, v221
v_cvt_pk_bf16_f32 v125, v222, v223
v_cvt_pk_bf16_f32 v126, v252, v253
v_cvt_pk_bf16_f32 v127, v254, v255
s_nop 0
v_permlane16_swap_b32 v124, v126
v_permlane16_swap_b32 v125, v127
buffer_store_dwordx4 v[124:127], v92, s[44:47], s58 offen offset:1024 sc1
v_mov_b64 v[128:129], 0
v_mov_b64 v[130:131], 0
v_mov_b64 v[132:133], 0
v_mov_b64 v[134:135], 0
v_mov_b64 v[136:137], 0
v_mov_b64 v[138:139], 0
v_mov_b64 v[140:141], 0
v_mov_b64 v[142:143], 0
v_mov_b64 v[144:145], 0
v_mov_b64 v[146:147], 0
v_mov_b64 v[148:149], 0
v_mov_b64 v[150:151], 0
v_mov_b64 v[152:153], 0
v_mov_b64 v[154:155], 0
v_mov_b64 v[156:157], 0
v_mov_b64 v[158:159], 0
v_mov_b64 v[160:161], 0
v_mov_b64 v[162:163], 0
v_mov_b64 v[164:165], 0
v_mov_b64 v[166:167], 0
v_mov_b64 v[168:169], 0
v_mov_b64 v[170:171], 0
v_mov_b64 v[172:173], 0
v_mov_b64 v[174:175], 0
v_mov_b64 v[176:177], 0
v_mov_b64 v[178:179], 0
v_mov_b64 v[180:181], 0
v_mov_b64 v[182:183], 0
v_mov_b64 v[184:185], 0
v_mov_b64 v[186:187], 0
v_mov_b64 v[188:189], 0
v_mov_b64 v[190:191], 0
v_mov_b64 v[192:193], 0
v_mov_b64 v[194:195], 0
v_mov_b64 v[196:197], 0
v_mov_b64 v[198:199], 0
v_mov_b64 v[200:201], 0
v_mov_b64 v[202:203], 0
v_mov_b64 v[204:205], 0
v_mov_b64 v[206:207], 0
v_mov_b64 v[208:209], 0
v_mov_b64 v[210:211], 0
v_mov_b64 v[212:213], 0
v_mov_b64 v[214:215], 0
v_mov_b64 v[216:217], 0
v_mov_b64 v[218:219], 0
v_mov_b64 v[220:221], 0
v_mov_b64 v[222:223], 0
v_mov_b64 v[224:225], 0
v_mov_b64 v[226:227], 0
v_mov_b64 v[228:229], 0
v_mov_b64 v[230:231], 0
v_mov_b64 v[232:233], 0
v_mov_b64 v[234:235], 0
v_mov_b64 v[236:237], 0
v_mov_b64 v[238:239], 0
v_mov_b64 v[240:241], 0
v_mov_b64 v[242:243], 0
v_mov_b64 v[244:245], 0
v_mov_b64 v[246:247], 0
v_mov_b64 v[248:249], 0
v_mov_b64 v[250:251], 0
v_mov_b64 v[252:253], 0
v_mov_b64 v[254:255], 0
s_mov_b32 s61, s74
s_mov_b32 s77, 1
s_cmp_eq_u32 s76, 2
s_cbranch_scc1 Lgn_80
s_branch Lgx_81
Lgs_78:
s_mov_b32 s74, s72
s_mov_b32 s75, s73
v_readlane_b32 s73, v1, s71
s_add_u32 s71, s71, 1
s_lshr_b32 s76, s73, 16
s_bfe_u32 s72, s73, 0x80008
s_and_b32 s73, s73, 255
s_mul_i32 s52, s72, 524288
s_mov_b32 s36, s14
s_mov_b32 s37, s15
s_mov_b32 s38, 4194304
s_add_u32 s36, s36, s52
s_addc_u32 s37, s37, 0
s_sub_u32 s38, s38, s52
s_and_b32 s37, s37, 0xffff
s_mov_b32 s39, 0x20000
s_lshr_b32 s53, s73, 5
s_and_b32 s54, s73, 31
s_cmp_eq_u32 s53, 1
s_cselect_b32 s56, s20, s18
s_cselect_b32 s57, s21, s19
s_cmp_eq_u32 s53, 2
s_cselect_b32 s56, s22, s56
s_cselect_b32 s57, s23, s57
s_lshl_b32 s52, s54, 8
s_mov_b32 s40, s56
s_mov_b32 s41, s57
s_mov_b32 s42, 8388608
s_add_u32 s40, s40, s52
s_addc_u32 s41, s41, 0
s_sub_u32 s42, s42, s52
s_and_b32 s41, s41, 0xffff
s_mov_b32 s43, 0x20000
s_cmp_eq_u32 s76, 2
s_cbranch_scc1 Lsw_84
s_mov_b32 s38, 0
s_mov_b32 s42, 0
Lsw_84:
s_branch Lgsb_79
Lgh_77:
s_sub_u32 s77, s77, 1
s_cmp_eq_u32 s77, 0
s_cbranch_scc1 Lgst_85
s_waitcnt vmcnt(16) lgkmcnt(0)
s_barrier
s_branch Lgb_76
Lgst_85:
s_waitcnt vmcnt(0) lgkmcnt(0)
s_barrier
s_cmp_lg_u32 s34, 0
s_cbranch_scc1 Lsig_86
s_lshl_b32 s58, s61, 3
v_lshl_add_u32 v92, v0, 2, s58
v_mov_b32 v93, 2
s_mov_b64 exec, 3
global_atomic_add v92, v93, s[30:31] offset:128
s_mov_b64 exec, -1
Lsig_86:
s_branch Lgb_76
Lgx_81:
s_waitcnt vmcnt(0) lgkmcnt(0)
s_barrier
s_cmp_lg_u32 s34, 0
s_cbranch_scc1 Lsig_87
s_lshl_b32 s58, s61, 3
v_lshl_add_u32 v92, v0, 2, s58
v_mov_b32 v93, 2
s_mov_b64 exec, 3
global_atomic_add v92, v93, s[30:31] offset:128
s_mov_b64 exec, -1
Lsig_87:
s_branch Ldisp
Ljob7:
s_add_u32 s52, s72, 960
s_lshl_b32 s52, s52, 3
s_add_u32 s52, s52, s34
s_lshl_b32 s52, s52, 12
v_lshlrev_b32 v2, 4, v0
v_mov_b64 v[4:5], -1
v_mov_b64 v[6:7], -1
s_add_u32 s44, s32, 100663296
s_addc_u32 s45, s33, 0
s_mov_b32 s46, 167772160
s_add_u32 s44, s44, s52
s_addc_u32 s45, s45, 0
s_sub_u32 s46, s46, s52
s_and_b32 s45, s45, 0xffff
s_mov_b32 s47, 0x20000
buffer_store_dwordx4 v[4:7], v2, s[44:47], 0 offen offset:0 sc1
buffer_store_dwordx4 v[4:7], v2, s[44:47], 0 offen offset:1024 sc1
buffer_store_dwordx4 v[4:7], v2, s[44:47], 0 offen offset:2048 sc1
buffer_store_dwordx4 v[4:7], v2, s[44:47], 0 offen offset:3072 sc1
s_nop 1
s_branch Lnext
Ljob3:
s_lshl_b32 s52, s72, 16
s_mov_b32 s36, s4
s_mov_b32 s37, s5
s_mov_b32 s38, 4194304
s_add_u32 s36, s36, s52
s_addc_u32 s37, s37, 0
s_sub_u32 s38, s38, s52
s_and_b32 s37, s37, 0xffff
s_mov_b32 s39, 0x20000
s_lshl_b32 s52, s34, 13
s_mov_b32 s40, s8
s_mov_b32 s41, s9
s_mov_b32 s42, 65536
s_add_u32 s40, s40, s52
s_addc_u32 s41, s41, 0
s_sub_u32 s42, s42, s52
s_and_b32 s41, s41, 0xffff
s_mov_b32 s43, 0x20000
s_mov_b32 s44, s10
s_mov_b32 s45, s11
s_mov_b32 s46, 65536
s_add_u32 s44, s44, s52
s_addc_u32 s45, s45, 0
s_sub_u32 s46, s46, s52
s_and_b32 s45, s45, 0xffff
s_mov_b32 s47, 0x20000
v_lshlrev_b32 v2, 4, v0
s_lshl_b32 s53, s34, 14
s_mov_b32 m0, s53
s_mov_b32 s54, 4096
buffer_load_dwordx4 v2, s[40:43], 0 offen offset:0 lds
buffer_load_dwordx4 v2, s[40:43], 0 offen offset:1024 lds
buffer_load_dwordx4 v2, s[40:43], 0 offen offset:2048 lds
buffer_load_dwordx4 v2, s[40:43], 0 offen offset:3072 lds
s_add_u32 m0, s53, 4096
s_nop 0
buffer_load_dwordx4 v2, s[40:43], s54 offen offset:0 lds
buffer_load_dwordx4 v2, s[40:43], s54 offen offset:1024 lds
buffer_load_dwordx4 v2, s[40:43], s54 offen offset:2048 lds
buffer_load_dwordx4 v2, s[40:43], s54 offen offset:3072 lds
s_add_u32 m0, s53, 8192
s_nop 0
buffer_load_dwordx4 v2, s[44:47], 0 offen offset:0 lds
buffer_load_dwordx4 v2, s[44:47], 0 offen offset:1024 lds
buffer_load_dwordx4 v2, s[44:47], 0 offen offset:2048 lds
buffer_load_dwordx4 v2, s[44:47], 0 offen offset:3072 lds
s_add_u32 m0, s53, 12288
s_nop 0
buffer_load_dwordx4 v2, s[44:47], s54 offen offset:0 lds
buffer_load_dwordx4 v2, s[44:47], s54 offen offset:1024 lds
buffer_load_dwordx4 v2, s[44:47], s54 offen offset:2048 lds
buffer_load_dwordx4 v2, s[44:47], s54 offen offset:3072 lds
v_and_b32 v3, 31, v0
v_lshlrev_b32 v3, 11, v3
v_lshrrev_b32 v4, 5, v0
v_lshl_add_u32 v3, v4, 4, v3
s_lshl_b32 s55, s34, 8
buffer_load_dwordx4 v[16:19], v3, s[36:39], s55 offen offset:0
buffer_load_dwordx4 v[20:23], v3, s[36:39], s55 offen offset:32
buffer_load_dwordx4 v[24:27], v3, s[36:39], s55 offen offset:64
buffer_load_dwordx4 v[28:31], v3, s[36:39], s55 offen offset:96
buffer_load_dwordx4 v[32:35], v3, s[36:39], s55 offen offset:128
buffer_load_dwordx4 v[36:39], v3, s[36:39], s55 offen offset:160
buffer_load_dwordx4 v[40:43], v3, s[36:39], s55 offen offset:192
buffer_load_dwordx4 v[44:47], v3, s[36:39], s55 offen offset:224
v_bfe_u32 v5, v0, 2, 2
v_lshl_add_u32 v5, v4, 3, v5
v_lshlrev_b32 v5, 6, v5
v_bfe_u32 v6, v0, 4, 1
v_lshl_add_u32 v5, v6, 5, v5
v_and_b32 v6, 3, v0
v_lshl_add_u32 v5, v6, 3, v5
v_add_u32 v5, s53, v5
s_waitcnt vmcnt(0)
ds_read_b64_tr_b16 v[48:49], v5 offset:0
ds_read_b64_tr_b16 v[50:51], v5 offset:256
ds_read_b64_tr_b16 v[52:53], v5 offset:8192
ds_read_b64_tr_b16 v[54:55], v5 offset:8448
s_waitcnt lgkmcnt(0)
v_mfma_f32_32x32x16_bf16 v[64:79], v[48:51], v[16:19], 0
v_mfma_f32_32x32x16_bf16 v[80:95], v[16:19], v[52:55], 0
ds_read_b64_tr_b16 v[56:57], v5 offset:1024
ds_read_b64_tr_b16 v[58:59], v5 offset:1280
ds_read_b64_tr_b16 v[60:61], v5 offset:9216
ds_read_b64_tr_b16 v[62:63], v5 offset:9472
s_waitcnt lgkmcnt(0)
v_mfma_f32_32x32x16_bf16 v[64:79], v[56:59], v[20:23], v[64:79]
v_mfma_f32_32x32x16_bf16 v[80:95], v[20:23], v[60:63], v[80:95]
ds_read_b64_tr_b16 v[48:49], v5 offset:2048
ds_read_b64_tr_b16 v[50:51], v5 offset:2304
ds_read_b64_tr_b16 v[52:53], v5 offset:10240
ds_read_b64_tr_b16 v[54:55], v5 offset:10496
s_waitcnt lgkmcnt(0)
v_mfma_f32_32x32x16_bf16 v[64:79], v[48:51], v[24:27], v[64:79]
v_mfma_f32_32x32x16_bf16 v[80:95], v[24:27], v[52:55], v[80:95]
ds_read_b64_tr_b16 v[56:57], v5 offset:3072
ds_read_b64_tr_b16 v[58:59], v5 offset:3328
ds_read_b64_tr_b16 v[60:61], v5 offset:11264
ds_read_b64_tr_b16 v[62:63], v5 offset:11520
s_waitcnt lgkmcnt(0)
v_mfma_f32_32x32x16_bf16 v[64:79], v[56:59], v[28:31], v[64:79]
v_mfma_f32_32x32x16_bf16 v[80:95], v[28:31], v[60:63], v[80:95]
ds_read_b64_tr_b16 v[48:49], v5 offset:4096
ds_read_b64_tr_b16 v[50:51], v5 offset:4352
ds_read_b64_tr_b16 v[52:53], v5 offset:12288
ds_read_b64_tr_b16 v[54:55], v5 offset:12544
s_waitcnt lgkmcnt(0)
v_mfma_f32_32x32x16_bf16 v[64:79], v[48:51], v[32:35], v[64:79]
v_mfma_f32_32x32x16_bf16 v[80:95], v[32:35], v[52:55], v[80:95]
ds_read_b64_tr_b16 v[56:57], v5 offset:5120
ds_read_b64_tr_b16 v[58:59], v5 offset:5376
ds_read_b64_tr_b16 v[60:61], v5 offset:13312
ds_read_b64_tr_b16 v[62:63], v5 offset:13568
s_waitcnt lgkmcnt(0)
v_mfma_f32_32x32x16_bf16 v[64:79], v[56:59], v[36:39], v[64:79]
v_mfma_f32_32x32x16_bf16 v[80:95], v[36:39], v[60:63], v[80:95]
ds_read_b64_tr_b16 v[48:49], v5 offset:6144
ds_read_b64_tr_b16 v[50:51], v5 offset:6400
ds_read_b64_tr_b16 v[52:53], v5 offset:14336
ds_read_b64_tr_b16 v[54:55], v5 offset:14592
s_waitcnt lgkmcnt(0)
v_mfma_f32_32x32x16_bf16 v[64:79], v[48:51], v[40:43], v[64:79]
v_mfma_f32_32x32x16_bf16 v[80:95], v[40:43], v[52:55], v[80:95]
ds_read_b64_tr_b16 v[56:57], v5 offset:7168
ds_read_b64_tr_b16 v[58:59], v5 offset:7424
ds_read_b64_tr_b16 v[60:61], v5 offset:15360
ds_read_b64_tr_b16 v[62:63], v5 offset:15616
s_waitcnt lgkmcnt(0)
v_mfma_f32_32x32x16_bf16 v[64:79], v[56:59], v[44:47], v[64:79]
v_mfma_f32_32x32x16_bf16 v[80:95], v[44:47], v[60:63], v[80:95]
v_add_u32 v6, s53, v2
s_nop 9
ds_write_b128 v6, v[64:67] offset:0
ds_write_b128 v6, v[68:71] offset:1024
ds_write_b128 v6, v[72:75] offset:2048
ds_write_b128 v6, v[76:79] offset:3072
ds_write_b128 v6, v[80:83] offset:4096
ds_write_b128 v6, v[84:87] offset:5120
ds_write_b128 v6, v[88:91] offset:6144
ds_write_b128 v6, v[92:95] offset:7168
s_waitcnt lgkmcnt(0)
s_barrier
s_cmp_gt_u32 s34, 3
s_cbranch_scc1 Lakv_88
s_lshl_b32 s53, s34, 11
v_add_u32 v6, s53, v2
v_add_u32 v7, 65536, v6
ds_read_b128 v[16:19], v6 offset:0
ds_read_b128 v[20:23], v6 offset:1024
ds_read_b128 v[24:27], v6 offset:16384
ds_read_b128 v[28:31], v6 offset:17408
ds_read_b128 v[32:35], v6 offset:32768
ds_read_b128 v[36:39], v6 offset:33792
ds_read_b128 v[40:43], v6 offset:49152
ds_read_b128 v[44:47], v6 offset:50176
ds_read_b128 v[48:51], v7 offset:0
ds_read_b128 v[52:55], v7 offset:1024
ds_read_b128 v[56:59], v7 offset:16384
ds_read_b128 v[60:63], v7 offset:17408
ds_read_b128 v[64:67], v7 offset:32768
ds_read_b128 v[68:71], v7 offset:33792
ds_read_b128 v[72:75], v7 offset:49152
ds_read_b128 v[76:79], v7 offset:50176
s_waitcnt lgkmcnt(0)
v_add_f32 v16, v16, v24
v_add_f32 v17, v17, v25
v_add_f32 v18, v18, v26
v_add_f32 v19, v19, v27
v_add_f32 v20, v20, v28
v_add_f32 v21, v21, v29
v_add_f32 v22, v22, v30
v_add_f32 v23, v23, v31
v_add_f32 v16, v16, v32
v_add_f32 v17, v17, v33
v_add_f32 v18, v18, v34
v_add_f32 v19, v19, v35
v_add_f32 v20, v20, v36
v_add_f32 v21, v21, v37
v_add_f32 v22, v22, v38
v_add_f32 v23, v23, v39
v_add_f32 v16, v16, v40
v_add_f32 v17, v17, v41
v_add_f32 v18, v18, v42
v_add_f32 v19, v19, v43
v_add_f32 v20, v20, v44
v_add_f32 v21, v21, v45
v_add_f32 v22, v22, v46
v_add_f32 v23, v23, v47
v_add_f32 v16, v16, v48
v_add_f32 v17, v17, v49
v_add_f32 v18, v18, v50
v_add_f32 v19, v19, v51
v_add_f32 v20, v20, v52
v_add_f32 v21, v21, v53
v_add_f32 v22, v22, v54
v_add_f32 v23, v23, v55
v_add_f32 v16, v16, v56
v_add_f32 v17, v17, v57
v_add_f32 v18, v18, v58
v_add_f32 v19, v19, v59
v_add_f32 v20, v20, v60
v_add_f32 v21, v21, v61
v_add_f32 v22, v22, v62
v_add_f32 v23, v23, v63
v_add_f32 v16, v16, v64
v_add_f32 v17, v17, v65
v_add_f32 v18, v18, v66
v_add_f32 v19, v19, v67
v_add_f32 v20, v20, v68
v_add_f32 v21, v21, v69
v_add_f32 v22, v22, v70
v_add_f32 v23, v23, v71
v_add_f32 v16, v16, v72
v_add_f32 v17, v17, v73
v_add_f32 v18, v18, v74
v_add_f32 v19, v19, v75
v_add_f32 v20, v20, v76
v_add_f32 v21, v21, v77
v_add_f32 v22, v22, v78
v_add_f32 v23, v23, v79
v_cvt_pk_bf16_f32 v16, v16, v17
v_cvt_pk_bf16_f32 v17, v18, v19
v_cvt_pk_bf16_f32 v18, v20, v21
v_cvt_pk_bf16_f32 v19, v22, v23
s_lshr_b32 s52, s34, 1
s_lshl_b32 s52, s52, 17
s_and_b32 s53, s34, 1
s_lshl_b32 s53, s53, 10
s_add_u32 s52, s52, s53
s_lshl_b32 s53, s72, 11
s_add_u32 s52, s52, s53
s_add_u32 s44, s32, 71303168
s_addc_u32 s45, s33, 0
s_mov_b32 s46, 197132288
s_add_u32 s44, s44, s52
s_addc_u32 s45, s45, 0
s_sub_u32 s46, s46, s52
s_and_b32 s45, s45, 0xffff
s_mov_b32 s47, 0x20000
buffer_store_dwordx4 v[16:19], v2, s[44:47], 0 offen sc1
Lakv_88:
s_waitcnt vmcnt(0)
s_barrier
s_cmp_lg_u32 s34, 0
s_cbranch_scc1 Lsig_89
v_mov_b32 v2, 0
v_mov_b32 v3, 1
s_mov_b64 exec, 1
global_atomic_add v2, v3, s[30:31] offset:68
s_mov_b64 exec, -1
Lsig_89:
s_branch Lnext
Ljob4:
s_lshl_b32 s52, s72, 18
s_mov_b32 s36, s4
s_mov_b32 s37, s5
s_mov_b32 s38, 4194304
s_add_u32 s36, s36, s52
s_addc_u32 s37, s37, 0
s_sub_u32 s38, s38, s52
s_and_b32 s37, s37, 0xffff
s_mov_b32 s39, 0x20000
s_lshl_b32 s52, s73, 8
s_mov_b32 s40, s6
s_mov_b32 s41, s7
s_mov_b32 s42, 2097152
s_add_u32 s40, s40, s52
s_addc_u32 s41, s41, 0
s_sub_u32 s42, s42, s52
s_and_b32 s41, s41, 0xffff
s_mov_b32 s43, 0x20000
s_lshr_b32 s48, s34, 2
s_and_b32 s49, s34, 3
s_mul_i32 s50, s34, 16
v_lshrrev_b32 v20, 3, v0
v_add_u32 v20, s50, v20
v_lshrrev_b32 v21, 1, v20
v_xor_b32 v21, v21, v0
v_and_b32 v21, 7, v21
v_lshlrev_b32 v21, 4, v21
v_mul_u32_u24 v20, 2048, v20
v_add_u32 v2, v20, v21
v_xor_b32 v21, 64, v21
v_add_u32 v21, v20, v21
v_add_u32 v3, 15360, v21
s_lshl_b32 s50, s34, 3
s_add_u32 s50, s50, 0
v_lshrrev_b32 v20, 4, v0
v_add_u32 v20, s50, v20
v_and_b32 v21, 3, v20
v_lshlrev_b32 v21, 2, v21
v_and_b32 v22, 15, v0
v_xor_b32 v21, v21, v22
v_mul_u32_u24 v20, 2048, v20
v_lshl_add_u32 v20, v21, 4, v20
v_subrev_u32 v4, 0, v20
s_lshl_b32 s50, s34, 3
s_add_u32 s50, s50, 4
v_lshrrev_b32 v20, 4, v0
v_add_u32 v20, s50, v20
v_and_b32 v21, 3, v20
v_lshlrev_b32 v21, 2, v21
v_and_b32 v22, 15, v0
v_xor_b32 v21, v21, v22
v_mul_u32_u24 v20, 2048, v20
v_lshl_add_u32 v20, v21, 4, v20
v_subrev_u32 v5, 1024, v20
s_mul_i32 s67, s34, 2048
s_mul_i32 s68, s34, 2048
s_add_u32 s68, s68, 81920
s_mul_i32 s65, s35, 1
s_and_b32 s65, s65, 15
s_mul_i32 s64, s65, 128
s_mul_i32 s65, s65, 131072
s_mov_b32 s69, 0
Lpro_90:
s_add_u32 s69, s69, 1
s_cmp_eq_u32 s69, 5
s_cselect_b32 s69, 0, s69
s_mov_b32 s62, 16384
s_cselect_b32 s62, 0xffff0000, s62
s_mov_b32 s63, 16384
s_cselect_b32 s63, 0xffff0000, s63
s_mov_b32 m0, s67
s_nop 0
buffer_load_dwordx4 v2, s[36:39], s64 offen offset:0  lds
buffer_load_dwordx4 v3, s[36:39], s64 offen offset:1024  lds
s_add_u32 s64, s64, 128
s_add_u32 s67, s67, s62
s_bitset0_b32 s64, 11
s_cmp_eq_u32 s69, 0
s_cbranch_scc1 Lprox_91
s_mov_b32 m0, s68
s_nop 0
buffer_load_dwordx4 v4, s[40:43], s65 offen offset:0 lds
buffer_load_dwordx4 v5, s[40:43], s65 offen offset:1024 lds
s_add_u32 s65, s65, 131072
s_add_u32 s68, s68, s63
s_bitset0_b32 s65, 21
s_branch Lpro_90
Lprox_91:
s_lshr_b32 s48, s34, 2
s_and_b32 s49, s34, 3
s_mul_i32 s50, s48, 8192
v_and_b32 v20, 31, v0
v_bfe_u32 v21, v0, 1, 3
v_lshrrev_b32 v22, 5, v0
v_xor_b32 v21, v21, v22
v_lshlrev_b32 v21, 4, v21
v_lshlrev_b32 v20, 7, v20
v_add_u32 v20, s50, v20
v_xor_b32 v22, 0, v21
v_add_u32 v6, v20, v22
v_xor_b32 v22, 32, v21
v_add_u32 v7, v20, v22
v_xor_b32 v22, 64, v21
v_add_u32 v8, v20, v22
v_xor_b32 v22, 96, v21
v_add_u32 v9, v20, v22
v_bfe_u32 v20, v0, 2, 2
v_lshrrev_b32 v21, 5, v0
v_lshl_add_u32 v21, v21, 3, v20
v_mul_u32_u24 v21, 256, v21
v_and_b32 v22, 3, v0
v_lshl_add_u32 v21, v22, 3, v21
v_bfe_u32 v22, v0, 4, 1
v_lshl_add_u32 v21, v22, 5, v21
v_add_u32 v21, 81920, v21
s_mul_i32 s50, s49, 1
s_add_u32 s51, s50, 0
v_xor_b32 v22, s51, v20
v_lshl_add_u32 v10, v22, 6, v21
v_mov_b64 v[128:129], 0
v_mov_b64 v[130:131], 0
v_mov_b64 v[132:133], 0
v_mov_b64 v[134:135], 0
v_mov_b64 v[136:137], 0
v_mov_b64 v[138:139], 0
v_mov_b64 v[140:141], 0
v_mov_b64 v[142:143], 0
v_mov_b64 v[144:145], 0
v_mov_b64 v[146:147], 0
v_mov_b64 v[148:149], 0
v_mov_b64 v[150:151], 0
v_mov_b64 v[152:153], 0
v_mov_b64 v[154:155], 0
v_mov_b64 v[156:157], 0
v_mov_b64 v[158:159], 0
s_mov_b32 s77, 0
s_waitcnt vmcnt(14)
s_barrier
ds_read_b64_tr_b16 v[40:41], v10 offset:0
ds_read_b64_tr_b16 v[42:43], v10 offset:1024
ds_read_b128 v[24:27], v6 offset:0
ds_read_b128 v[28:31], v6 offset:4096
s_mov_b32 s66, 0
s_branch Lgn_97
.p2align 6
Lg_92:
s_waitcnt vmcnt(12) lgkmcnt(0)
s_barrier
Lgb_93:
v_mfma_f32_32x32x16_bf16 v[128:143], v[44:47], v[32:35], v[128:143]
ds_read_b64_tr_b16 v[40:41], v10 offset:0
ds_read_b64_tr_b16 v[42:43], v10 offset:1024
s_mov_b32 m0, s67
s_nop 0
buffer_load_dwordx4 v2, s[36:39], s64 offen offset:0  lds
ds_read_b128 v[24:27], v6 offset:0
v_mfma_f32_32x32x16_bf16 v[144:159], v[44:47], v[36:39], v[144:159]
ds_read_b128 v[28:31], v6 offset:4096
buffer_load_dwordx4 v3, s[36:39], s64 offen offset:1024  lds
s_add_u32 s64, s64, 128
s_add_u32 s67, s67, s62
s_bitset0_b32 s64, 11
s_add_u32 s66, s66, 1
s_cmp_eq_u32 s66, 16
s_cbranch_scc1 Lge_99
Lgn_97:
s_waitcnt lgkmcnt(0)
v_mfma_f32_32x32x16_bf16 v[128:143], v[40:43], v[24:27], v[128:143]
ds_read_b64_tr_b16 v[44:45], v10 offset:4096
ds_read_b64_tr_b16 v[46:47], v10 offset:5120
s_mov_b32 m0, s68
s_nop 0
buffer_load_dwordx4 v4, s[40:43], s65 offen offset:0 lds
v_mfma_f32_32x32x16_bf16 v[144:159], v[40:43], v[28:31], v[144:159]
ds_read_b128 v[32:35], v7 offset:0
ds_read_b128 v[36:39], v7 offset:4096
buffer_load_dwordx4 v5, s[40:43], s65 offen offset:1024 lds
s_add_u32 s65, s65, 131072
s_add_u32 s68, s68, s63
s_bitset0_b32 s65, 21
s_waitcnt lgkmcnt(0)
v_mfma_f32_32x32x16_bf16 v[128:143], v[44:47], v[32:35], v[128:143]
ds_read_b64_tr_b16 v[40:41], v10 offset:8192
ds_read_b64_tr_b16 v[42:43], v10 offset:9216
v_mfma_f32_32x32x16_bf16 v[144:159], v[44:47], v[36:39], v[144:159]
ds_read_b128 v[24:27], v8 offset:0
ds_read_b128 v[28:31], v8 offset:4096
s_waitcnt lgkmcnt(0)
v_mfma_f32_32x32x16_bf16 v[128:143], v[40:43], v[24:27], v[128:143]
ds_read_b64_tr_b16 v[44:45], v10 offset:12288
ds_read_b64_tr_b16 v[46:47], v10 offset:13312
ds_read_b128 v[32:35], v9 offset:0
ds_read_b128 v[36:39], v9 offset:4096
s_add_u32 s69, s69, 1
s_cmp_eq_u32 s69, 5
s_cselect_b32 s69, 0, s69
s_mov_b32 s62, 16384
s_cselect_b32 s62, 0xffff0000, s62
s_mov_b32 s63, 16384
s_cselect_b32 s63, 0xffff0000, s63
v_mfma_f32_32x32x16_bf16 v[144:159], v[40:43], v[28:31], v[144:159]
v_add_u32 v6, s62, v6
v_add_u32 v7, s62, v7
v_add_u32 v8, s62, v8
v_add_u32 v9, s62, v9
v_add_u32 v10, s63, v10
s_cmp_eq_u32 s66, 11
s_cbranch_scc1 Lgs_95
Lgsb_96:
s_cmp_eq_u32 s77, 0
s_cbranch_scc1 Lg_92
s_branch Lgh_94
Lge_99:
s_mov_b32 s66, 0
s_branch Lgx_98
Lgs_95:
s_mov_b32 s38, 0
s_mov_b32 s42, 0
s_branch Lgsb_96
Lgh_94:
s_sub_u32 s77, s77, 1
s_cmp_eq_u32 s77, 0
s_cbranch_scc1 Lgst_100
s_waitcnt vmcnt(12) lgkmcnt(0)
s_barrier
s_branch Lgb_93
Lgst_100:
s_waitcnt vmcnt(2) lgkmcnt(0)
s_barrier
s_branch Lgb_93
Lgx_98:
s_waitcnt vmcnt(0) lgkmcnt(0)
s_mov_b32 s50, 0x3e8293ee
s_barrier
s_cmp_lg_u32 s34, 0
s_cbranch_scc1 Lwt_101
v_mov_b32 v2, 0
Lpoll_102:
global_load_dword v3, v2, s[30:31] offset:68 sc1
s_add_u32 s79, s79, 1
s_cmp_gt_u32 s79, 400000
s_cbranch_scc1 Lwfail
s_waitcnt vmcnt(0)
v_readfirstlane_b32 s48, v3
s_nop 0
s_cmp_ge_u32 s48, 64
s_cbranch_scc1 Lok_103
s_sleep 8
s_branch Lpoll_102
Lok_103:
Lwt_101:
s_barrier
s_add_u32 s36, s32, 71303168
s_addc_u32 s37, s33, 0
s_mov_b32 s38, 262144
s_and_b32 s37, s37, 0xffff
s_mov_b32 s39, 0x20000
v_lshlrev_b32 v2, 4, v0
s_lshl_b32 s53, s34, 12
s_mov_b32 s54, s53
Lkld_104:
s_mov_b32 m0, s54
s_nop 0
buffer_load_dwordx4 v2, s[36:39], s54 offen offset:0 sc1 lds
buffer_load_dwordx4 v2, s[36:39], s54 offen offset:1024 sc1 lds
buffer_load_dwordx4 v2, s[36:39], s54 offen offset:2048 sc1 lds
buffer_load_dwordx4 v2, s[36:39], s54 offen offset:3072 sc1 lds
s_add_u32 s54, s54, 32768
s_cmp_lt_u32 s54, 131072
s_cbranch_scc1 Lkld_104
v_mul_f32 v128, s50, v128
v_mul_f32 v129, s50, v129
v_mul_f32 v130, s50, v130
v_mul_f32 v131, s50, v131
v_mul_f32 v132, s50, v132
v_mul_f32 v133, s50, v133
v_mul_f32 v134, s50, v134
v_mul_f32 v135, s50, v135
v_mul_f32 v136, s50, v136
v_mul_f32 v137, s50, v137
v_mul_f32 v138, s50, v138
v_mul_f32 v139, s50, v139
v_mul_f32 v140, s50, v140
v_mul_f32 v141, s50, v141
v_mul_f32 v142, s50, v142
v_mul_f32 v143, s50, v143
v_cvt_pk_bf16_f32 v8, v128, v129
v_cvt_pk_bf16_f32 v9, v130, v131
v_cvt_pk_bf16_f32 v10, v132, v133
v_cvt_pk_bf16_f32 v11, v134, v135
v_cvt_pk_bf16_f32 v12, v136, v137
v_cvt_pk_bf16_f32 v13, v138, v139
v_cvt_pk_bf16_f32 v14, v140, v141
v_cvt_pk_bf16_f32 v15, v142, v143
v_mul_f32 v144, s50, v144
v_mul_f32 v145, s50, v145
v_mul_f32 v146, s50, v146
v_mul_f32 v147, s50, v147
v_mul_f32 v148, s50, v148
v_mul_f32 v149, s50, v149
v_mul_f32 v150, s50, v150
v_mul_f32 v151, s50, v151
v_mul_f32 v152, s50, v152
v_mul_f32 v153, s50, v153
v_mul_f32 v154, s50, v154
v_mul_f32 v155, s50, v155
v_mul_f32 v156, s50, v156
v_mul_f32 v157, s50, v157
v_mul_f32 v158, s50, v158
v_mul_f32 v159, s50, v159
v_cvt_pk_bf16_f32 v16, v144, v145
v_cvt_pk_bf16_f32 v17, v146, v147
v_cvt_pk_bf16_f32 v18, v148, v149
v_cvt_pk_bf16_f32 v19, v150, v151
v_cvt_pk_bf16_f32 v20, v152, v153
v_cvt_pk_bf16_f32 v21, v154, v155
v_cvt_pk_bf16_f32 v22, v156, v157
v_cvt_pk_bf16_f32 v23, v158, v159
v_mov_b32 v72, 0x3f803f80
v_mov_b32 v73, 0x3f803f80
v_mov_b32 v74, 0x3f803f80
v_mov_b32 v75, 0x3f803f80
s_mov_b32 s59, 3
Lredo_105:
s_lshl_b32 s55, s34, 11
s_add_u32 s55, s55, 131072
s_mov_b32 s56, s55
s_mov_b32 m0, s55
s_xor_b32 s55, s55, 16384
buffer_load_dwordx4 v2, s[36:39], s56 offen sc1 lds
buffer_load_dwordx4 v2, s[36:39], s56 offen offset:1024 sc1 lds
s_add_u32 s56, s56, 16384
v_mov_b32 v4, 0xff800000
v_mov_b32 v5, 0xff800000
v_mov_b32 v3, v2
s_waitcnt vmcnt(2)
s_barrier
ds_read_b128 v[40:43], v3 offset:0
ds_read_b128 v[44:47], v3 offset:1024
v_mov_b32 v176, 0xff800000
v_mov_b32 v177, 0xff800000
v_mov_b32 v178, 0xff800000
v_mov_b32 v179, 0xff800000
v_mov_b32 v180, 0xff800000
v_mov_b32 v181, 0xff800000
v_mov_b32 v182, 0xff800000
v_mov_b32 v183, 0xff800000
v_mov_b32 v184, 0xff800000
v_mov_b32 v185, 0xff800000
v_mov_b32 v186, 0xff800000
v_mov_b32 v187, 0xff800000
v_mov_b32 v188, 0xff800000
v_mov_b32 v189, 0xff800000
v_mov_b32 v190, 0xff800000
v_mov_b32 v191, 0xff800000
v_mov_b32 v192, 0xff800000
v_mov_b32 v193, 0xff800000
v_mov_b32 v194, 0xff800000
v_mov_b32 v195, 0xff800000
v_mov_b32 v196, 0xff800000
v_mov_b32 v197, 0xff800000
v_mov_b32 v198, 0xff800000
v_mov_b32 v199, 0xff800000
v_mov_b32 v200, 0xff800000
v_mov_b32 v201, 0xff800000
v_mov_b32 v202, 0xff800000
v_mov_b32 v203, 0xff800000
v_mov_b32 v204, 0xff800000
v_mov_b32 v205, 0xff800000
v_mov_b32 v206, 0xff800000
v_mov_b32 v207, 0xff800000
s_mov_b32 s57, s59
Lp1_106:
s_waitcnt lgkmcnt(0)
v_mfma_f32_32x32x16_bf16 v[80:95], v[40:43], v[8:11], 0
ds_read_b128 v[48:51], v3 offset:2048
ds_read_b128 v[52:55], v3 offset:3072
v_max3_f32 v4, v176, v177, v4
v_max3_f32 v4, v178, v179, v4
v_max3_f32 v4, v180, v181, v4
v_mfma_f32_32x32x16_bf16 v[80:95], v[44:47], v[12:15], v[80:95]
v_max3_f32 v4, v182, v183, v4
v_max3_f32 v4, v184, v185, v4
v_max3_f32 v4, v186, v187, v4
v_max3_f32 v4, v188, v189, v4
v_max3_f32 v4, v190, v191, v4
v_mfma_f32_32x32x16_bf16 v[96:111], v[40:43], v[16:19], 0
v_max3_f32 v5, v192, v193, v5
v_max3_f32 v5, v194, v195, v5
v_max3_f32 v5, v196, v197, v5
v_max3_f32 v5, v198, v199, v5
v_max3_f32 v5, v200, v201, v5
v_mfma_f32_32x32x16_bf16 v[96:111], v[44:47], v[20:23], v[96:111]
v_max3_f32 v5, v202, v203, v5
v_max3_f32 v5, v204, v205, v5
v_max3_f32 v5, v206, v207, v5
s_waitcnt lgkmcnt(0)
v_mfma_f32_32x32x16_bf16 v[176:191], v[48:51], v[8:11], 0
ds_read_b128 v[40:43], v3 offset:4096
ds_read_b128 v[44:47], v3 offset:5120
v_add_u32 v3, 4096, v3
v_max3_f32 v4, v80, v81, v4
v_max3_f32 v4, v82, v83, v4
v_mfma_f32_32x32x16_bf16 v[176:191], v[52:55], v[12:15], v[176:191]
v_max3_f32 v4, v84, v85, v4
v_max3_f32 v4, v86, v87, v4
v_max3_f32 v4, v88, v89, v4
v_max3_f32 v4, v90, v91, v4
v_max3_f32 v4, v92, v93, v4
v_mfma_f32_32x32x16_bf16 v[192:207], v[48:51], v[16:19], 0
v_max3_f32 v4, v94, v95, v4
v_max3_f32 v5, v96, v97, v5
v_max3_f32 v5, v98, v99, v5
v_max3_f32 v5, v100, v101, v5
v_max3_f32 v5, v102, v103, v5
v_mfma_f32_32x32x16_bf16 v[192:207], v[52:55], v[20:23], v[192:207]
v_max3_f32 v5, v104, v105, v5
v_max3_f32 v5, v106, v107, v5
v_max3_f32 v5, v108, v109, v5
v_max3_f32 v5, v110, v111, v5
s_sub_u32 s57, s57, 1
s_cmp_lg_u32 s57, 0
s_cbranch_scc1 Lp1_106
s_nop 7
s_nop 3
v_max3_f32 v4, v176, v177, v4
v_max3_f32 v4, v178, v179, v4
v_max3_f32 v4, v180, v181, v4
v_max3_f32 v4, v182, v183, v4
v_max3_f32 v4, v184, v185, v4
v_max3_f32 v4, v186, v187, v4
v_max3_f32 v4, v188, v189, v4
v_max3_f32 v4, v190, v191, v4
v_max3_f32 v5, v192, v193, v5
v_max3_f32 v5, v194, v195, v5
v_max3_f32 v5, v196, v197, v5
v_max3_f32 v5, v198, v199, v5
v_max3_f32 v5, v200, v201, v5
v_max3_f32 v5, v202, v203, v5
v_max3_f32 v5, v204, v205, v5
v_max3_f32 v5, v206, v207, v5
v_mov_b32 v6, v4
s_nop 1
v_permlane32_swap_b32 v4, v6
v_max_f32 v4, v4, v6
v_add_f32 v4, 0x42800000, v4
v_mul_f32 v112, -1.0, v4
v_mul_f32 v113, -1.0, v4
v_mul_f32 v114, -1.0, v4
v_mul_f32 v115, -1.0, v4
v_mul_f32 v116, -1.0, v4
v_mul_f32 v117, -1.0, v4
v_mul_f32 v118, -1.0, v4
v_mul_f32 v119, -1.0, v4
v_mul_f32 v120, -1.0, v4
v_mul_f32 v121, -1.0, v4
v_mul_f32 v122, -1.0, v4
v_mul_f32 v123, -1.0, v4
v_mul_f32 v124, -1.0, v4
v_mul_f32 v125, -1.0, v4
v_mul_f32 v126, -1.0, v4
v_mul_f32 v127, -1.0, v4
v_mov_b64 v[176:177], 0
v_mov_b64 v[208:209], 0
v_mov_b64 v[178:179], 0
v_mov_b64 v[210:211], 0
v_mov_b64 v[180:181], 0
v_mov_b64 v[212:213], 0
v_mov_b64 v[182:183], 0
v_mov_b64 v[214:215], 0
v_mov_b64 v[184:185], 0
v_mov_b64 v[216:217], 0
v_mov_b64 v[186:187], 0
v_mov_b64 v[218:219], 0
v_mov_b64 v[188:189], 0
v_mov_b64 v[220:221], 0
v_mov_b64 v[190:191], 0
v_mov_b64 v[222:223], 0
v_mov_b32 v6, v5
s_nop 1
v_permlane32_swap_b32 v5, v6
v_max_f32 v5, v5, v6
v_add_f32 v5, 0x42800000, v5
v_mul_f32 v160, -1.0, v5
v_mul_f32 v161, -1.0, v5
v_mul_f32 v162, -1.0, v5
v_mul_f32 v163, -1.0, v5
v_mul_f32 v164, -1.0, v5
v_mul_f32 v165, -1.0, v5
v_mul_f32 v166, -1.0, v5
v_mul_f32 v167, -1.0, v5
v_mul_f32 v168, -1.0, v5
v_mul_f32 v169, -1.0, v5
v_mul_f32 v170, -1.0, v5
v_mul_f32 v171, -1.0, v5
v_mul_f32 v172, -1.0, v5
v_mul_f32 v173, -1.0, v5
v_mul_f32 v174, -1.0, v5
v_mul_f32 v175, -1.0, v5
v_mov_b64 v[192:193], 0
v_mov_b64 v[224:225], 0
v_mov_b64 v[194:195], 0
v_mov_b64 v[226:227], 0
v_mov_b64 v[196:197], 0
v_mov_b64 v[228:229], 0
v_mov_b64 v[198:199], 0
v_mov_b64 v[230:231], 0
v_mov_b64 v[200:201], 0
v_mov_b64 v[232:233], 0
v_mov_b64 v[202:203], 0
v_mov_b64 v[234:235], 0
v_mov_b64 v[204:205], 0
v_mov_b64 v[236:237], 0
v_mov_b64 v[206:207], 0
v_mov_b64 v[238:239], 0
v_mov_b64 v[32:33], 0
v_mov_b64 v[64:65], 0
v_mov_b64 v[34:35], 0
v_mov_b64 v[66:67], 0
v_mov_b64 v[36:37], 0
v_mov_b64 v[68:69], 0
v_mov_b64 v[38:39], 0
v_mov_b64 v[70:71], 0
s_waitcnt lgkmcnt(0)
v_mov_b32 v3, v2
v_add_u32 v7, 131072, v2
ds_read_b128 v[40:43], v3 offset:0
ds_read_b128 v[44:47], v3 offset:1024
ds_read_b128 v[48:51], v3 offset:2048
ds_read_b128 v[52:55], v3 offset:3072
s_waitcnt lgkmcnt(0)
v_mfma_f32_32x32x16_bf16 v[80:95], v[40:43], v[8:11], v[112:127]
v_mfma_f32_32x32x16_bf16 v[80:95], v[44:47], v[12:15], v[80:95]
s_mov_b32 s57, 0
s_mov_b32 s51, 0x27fff
Lp2_107:
s_and_b32 s52, s57, 3
s_cbranch_scc0 Lp2c_108
Lp2b_109:
v_mfma_f32_32x32x16_bf16 v[96:111], v[40:43], v[16:19], v[160:175]
ds_read_b128 v[56:59], v7 offset:0
ds_read_b128 v[60:63], v7 offset:1024
s_nop 4
v_exp_f32 v80, v80
v_exp_f32 v81, v81
v_exp_f32 v82, v82
v_mfma_f32_32x32x16_bf16 v[96:111], v[44:47], v[20:23], v[96:111]
v_exp_f32 v83, v83
v_cvt_pk_bf16_f32 v24, v80, v81
v_exp_f32 v84, v84
v_exp_f32 v85, v85
v_cvt_pk_bf16_f32 v25, v82, v83
v_mfma_f32_32x32x16_bf16 v[192:207], v[64:67], v[32:35], v[192:207]
v_exp_f32 v86, v86
v_exp_f32 v87, v87
v_cvt_pk_bf16_f32 v26, v84, v85
v_exp_f32 v88, v88
v_exp_f32 v89, v89
v_mfma_f32_32x32x16_bf16 v[224:239], v[72:75], v[32:35], v[224:239]
v_cvt_pk_bf16_f32 v27, v86, v87
v_exp_f32 v90, v90
v_exp_f32 v91, v91
v_cvt_pk_bf16_f32 v28, v88, v89
v_exp_f32 v92, v92
v_mfma_f32_32x32x16_bf16 v[192:207], v[68:71], v[36:39], v[192:207]
v_exp_f32 v93, v93
v_cvt_pk_bf16_f32 v29, v90, v91
v_exp_f32 v94, v94
v_exp_f32 v95, v95
v_cvt_pk_bf16_f32 v30, v92, v93
v_mfma_f32_32x32x16_bf16 v[224:239], v[72:75], v[36:39], v[224:239]
s_nop 0
v_cvt_pk_bf16_f32 v31, v94, v95
s_waitcnt lgkmcnt(0)
v_mfma_f32_32x32x16_bf16 v[80:95], v[48:51], v[8:11], v[112:127]
v_exp_f32 v96, v96
v_exp_f32 v97, v97
v_exp_f32 v98, v98
v_exp_f32 v99, v99
v_cvt_pk_bf16_f32 v32, v96, v97
v_mfma_f32_32x32x16_bf16 v[80:95], v[52:55], v[12:15], v[80:95]
v_exp_f32 v100, v100
v_exp_f32 v101, v101
v_cvt_pk_bf16_f32 v33, v98, v99
v_exp_f32 v102, v102
v_exp_f32 v103, v103
v_mfma_f32_32x32x16_bf16 v[176:191], v[56:59], v[24:27], v[176:191]
ds_read_b128 v[40:43], v3 offset:4096
ds_read_b128 v[44:47], v3 offset:5120
v_cvt_pk_bf16_f32 v34, v100, v101
v_exp_f32 v104, v104
v_exp_f32 v105, v105
v_mfma_f32_32x32x16_bf16 v[208:223], v[72:75], v[24:27], v[208:223]
v_cvt_pk_bf16_f32 v35, v102, v103
v_exp_f32 v106, v106
v_exp_f32 v107, v107
v_cvt_pk_bf16_f32 v36, v104, v105
v_exp_f32 v108, v108
v_mfma_f32_32x32x16_bf16 v[176:191], v[60:63], v[28:31], v[176:191]
v_exp_f32 v109, v109
v_cvt_pk_bf16_f32 v37, v106, v107
v_exp_f32 v110, v110
v_exp_f32 v111, v111
v_cvt_pk_bf16_f32 v38, v108, v109
v_mfma_f32_32x32x16_bf16 v[208:223], v[72:75], v[28:31], v[208:223]
s_nop 0
v_cvt_pk_bf16_f32 v39, v110, v111
v_mfma_f32_32x32x16_bf16 v[96:111], v[48:51], v[16:19], v[160:175]
ds_read_b128 v[64:67], v7 offset:2048
ds_read_b128 v[68:71], v7 offset:3072
v_add_u32 v7, 4096, v7
v_and_b32 v7, s51, v7
v_exp_f32 v80, v80
v_mfma_f32_32x32x16_bf16 v[96:111], v[52:55], v[20:23], v[96:111]
v_exp_f32 v81, v81
v_exp_f32 v82, v82
v_exp_f32 v83, v83
v_cvt_pk_bf16_f32 v24, v80, v81
v_exp_f32 v84, v84
v_mfma_f32_32x32x16_bf16 v[192:207], v[56:59], v[32:35], v[192:207]
v_exp_f32 v85, v85
v_cvt_pk_bf16_f32 v25, v82, v83
v_exp_f32 v86, v86
v_exp_f32 v87, v87
v_cvt_pk_bf16_f32 v26, v84, v85
v_mfma_f32_32x32x16_bf16 v[224:239], v[72:75], v[32:35], v[224:239]
v_exp_f32 v88, v88
v_exp_f32 v89, v89
v_cvt_pk_bf16_f32 v27, v86, v87
v_exp_f32 v90, v90
v_exp_f32 v91, v91
v_mfma_f32_32x32x16_bf16 v[192:207], v[60:63], v[36:39], v[192:207]
v_cvt_pk_bf16_f32 v28, v88, v89
v_exp_f32 v92, v92
v_exp_f32 v93, v93
v_cvt_pk_bf16_f32 v29, v90, v91
v_exp_f32 v94, v94
v_mfma_f32_32x32x16_bf16 v[224:239], v[72:75], v[36:39], v[224:239]
v_exp_f32 v95, v95
v_cvt_pk_bf16_f32 v30, v92, v93
s_nop 0
v_cvt_pk_bf16_f32 v31, v94, v95
s_waitcnt lgkmcnt(0)
v_mfma_f32_32x32x16_bf16 v[80:95], v[40:43], v[8:11], v[112:127]
v_exp_f32 v96, v96
v_exp_f32 v97, v97
v_exp_f32 v98, v98
v_exp_f32 v99, v99
v_cvt_pk_bf16_f32 v32, v96, v97
v_mfma_f32_32x32x16_bf16 v[80:95], v[44:47], v[12:15], v[80:95]
v_exp_f32 v100, v100
v_exp_f32 v101, v101
v_cvt_pk_bf16_f32 v33, v98, v99
v_exp_f32 v102, v102
v_exp_f32 v103, v103
v_mfma_f32_32x32x16_bf16 v[176:191], v[64:67], v[24:27], v[176:191]
ds_read_b128 v[48:51], v3 offset:6144
ds_read_b128 v[52:55], v3 offset:7168
v_add_u32 v3, 4096, v3
v_cvt_pk_bf16_f32 v34, v100, v101
v_exp_f32 v104, v104
v_mfma_f32_32x32x16_bf16 v[208:223], v[72:75], v[24:27], v[208:223]
v_exp_f32 v105, v105
v_cvt_pk_bf16_f32 v35, v102, v103
v_exp_f32 v106, v106
v_exp_f32 v107, v107
v_cvt_pk_bf16_f32 v36, v104, v105
v_mfma_f32_32x32x16_bf16 v[176:191], v[68:71], v[28:31], v[176:191]
v_exp_f32 v108, v108
v_exp_f32 v109, v109
v_cvt_pk_bf16_f32 v37, v106, v107
v_exp_f32 v110, v110
v_exp_f32 v111, v111
v_mfma_f32_32x32x16_bf16 v[208:223], v[72:75], v[28:31], v[208:223]
v_cvt_pk_bf16_f32 v38, v108, v109
s_nop 0
v_cvt_pk_bf16_f32 v39, v110, v111
s_add_u32 s57, s57, 1
s_cmp_lg_u32 s57, 32
s_cbranch_scc1 Lp2_107
s_branch Lp2x_110
Lp2c_108:
s_waitcnt vmcnt(0) lgkmcnt(0)
s_barrier
s_mov_b32 m0, s55
s_xor_b32 s55, s55, 16384
buffer_load_dwordx4 v2, s[36:39], s56 offen sc1 lds
buffer_load_dwordx4 v2, s[36:39], s56 offen offset:1024 sc1 lds
s_add_u32 s56, s56, 16384
s_branch Lp2b_109
Lp2x_110:
v_mfma_f32_32x32x16_bf16 v[192:207], v[64:67], v[32:35], v[192:207]
v_mfma_f32_32x32x16_bf16 v[224:239], v[72:75], v[32:35], v[224:239]
v_mfma_f32_32x32x16_bf16 v[192:207], v[68:71], v[36:39], v[192:207]
v_mfma_f32_32x32x16_bf16 v[224:239], v[72:75], v[36:39], v[224:239]
s_waitcnt vmcnt(0) lgkmcnt(0)
s_mov_b32 s52, 0x71800000
s_lshl_b32 s55, s34, 11
v_and_b32 v7, 7, v0
v_lshlrev_b32 v7, 11, v7
v_add_u32 v7, 131072, v7
s_add_u32 s55, s55, 131072
v_mov_b32 v6, s55
v_cmp_ngt_f32 vcc, s52, v208
s_nop 2
v_cmp_ngt_f32 s[56:57], s52, v224
s_nop 0
s_or_b64 vcc, vcc, s[56:57]
s_cselect_b32 s52, 1, 0
v_mov_b32 v4, s52
ds_write_b32 v6, v4
s_waitcnt lgkmcnt(0)
s_barrier
ds_read_b32 v4, v7
s_waitcnt lgkmcnt(0)
v_cmp_ne_u32 vcc, 0, v4
s_cbranch_vccz Laok_111
s_cmp_eq_u32 s59, 32
s_cbranch_scc1 Laok_111
s_mov_b32 s59, 32
s_barrier
s_branch Lredo_105
Laok_111:
s_lshr_b32 s60, s34, 2
s_and_b32 s61, s34, 3
s_lshl_b32 s58, s72, 2
s_lshl_b32 s59, s60, 1
s_add_u32 s58, s58, s59
s_lshl_b32 s58, s58, 16
s_lshl_b32 s59, s73, 2
s_add_u32 s59, s59, s61
s_lshl_b32 s59, s59, 11
s_add_u32 s58, s58, s59
s_mov_b32 s59, 65536
v_lshlrev_b32 v92, 4, v0
s_add_u32 s44, s32, 67108864
s_addc_u32 s45, s33, 0
s_mov_b32 s46, 201326592
s_add_u32 s44, s44, s58
s_addc_u32 s45, s45, 0
s_sub_u32 s46, s46, s58
s_and_b32 s45, s45, 0xffff
s_mov_b32 s47, 0x20000
v_rcp_f32 v93, v208
s_nop 0
v_mul_f32 v176, v176, v93
v_mul_f32 v177, v177, v93
v_mul_f32 v178, v178, v93
v_mul_f32 v179, v179, v93
v_mul_f32 v180, v180, v93
v_mul_f32 v181, v181, v93
v_mul_f32 v182, v182, v93
v_mul_f32 v183, v183, v93
v_mul_f32 v184, v184, v93
v_mul_f32 v185, v185, v93
v_mul_f32 v186, v186, v93
v_mul_f32 v187, v187, v93
v_mul_f32 v188, v188, v93
v_mul_f32 v189, v189, v93
v_mul_f32 v190, v190, v93
v_mul_f32 v191, v191, v93
v_cvt_pk_bf16_f32 v96, v176, v177
v_cvt_pk_bf16_f32 v97, v178, v179
v_cvt_pk_bf16_f32 v98, v180, v181
v_cvt_pk_bf16_f32 v99, v182, v183
v_cvt_pk_bf16_f32 v100, v184, v185
v_cvt_pk_bf16_f32 v101, v186, v187
v_cvt_pk_bf16_f32 v102, v188, v189
v_cvt_pk_bf16_f32 v103, v190, v191
buffer_store_dwordx4 v[96:99], v92, s[44:47], 0 offen offset:0 sc1
buffer_store_dwordx4 v[100:103], v92, s[44:47], 0 offen offset:1024 sc1
v_rcp_f32 v93, v224
s_nop 0
v_mul_f32 v192, v192, v93
v_mul_f32 v193, v193, v93
v_mul_f32 v194, v194, v93
v_mul_f32 v195, v195, v93
v_mul_f32 v196, v196, v93
v_mul_f32 v197, v197, v93
v_mul_f32 v198, v198, v93
v_mul_f32 v199, v199, v93
v_mul_f32 v200, v200, v93
v_mul_f32 v201, v201, v93
v_mul_f32 v202, v202, v93
v_mul_f32 v203, v203, v93
v_mul_f32 v204, v204, v93
v_mul_f32 v205, v205, v93
v_mul_f32 v206, v206, v93
v_mul_f32 v207, v207, v93
v_cvt_pk_bf16_f32 v104, v192, v193
v_cvt_pk_bf16_f32 v105, v194, v195
v_cvt_pk_bf16_f32 v106, v196, v197
v_cvt_pk_bf16_f32 v107, v198, v199
v_cvt_pk_bf16_f32 v108, v200, v201
v_cvt_pk_bf16_f32 v109, v202, v203
v_cvt_pk_bf16_f32 v110, v204, v205
v_cvt_pk_bf16_f32 v111, v206, v207
buffer_store_dwordx4 v[104:107], v92, s[44:47], s59 offen offset:0 sc1
buffer_store_dwordx4 v[108:111], v92, s[44:47], s59 offen offset:1024 sc1
s_waitcnt vmcnt(0)
s_barrier
s_cmp_lg_u32 s34, 0
s_cbranch_scc1 Lsig_112
s_lshl_b32 s48, s72, 2
v_mov_b32 v2, s48
v_mov_b32 v3, 1
s_mov_b64 exec, 1
global_atomic_add v2, v3, s[30:31] offset:192
s_mov_b64 exec, -1
Lsig_112:
s_branch Lnext
Ljob5:
s_cmp_lg_u32 s34, 0
s_cbranch_scc1 Lwt_113
s_lshl_b32 s48, s72, 2
v_mov_b32 v2, s48
Lpoll_114:
global_load_dword v3, v2, s[30:31] offset:192 sc1
s_add_u32 s79, s79, 1
s_cmp_gt_u32 s79, 400000
s_cbranch_scc1 Lwfail
s_waitcnt vmcnt(0)
v_readfirstlane_b32 s48, v3
s_nop 0
s_cmp_ge_u32 s48, 8
s_cbranch_scc1 Lok_115
s_sleep 8
s_branch Lpoll_114
Lok_115:
Lwt_113:
s_barrier
s_mul_i32 s52, s72, 262144
s_add_u32 s36, s32, 67108864
s_addc_u32 s37, s33, 0
s_mov_b32 s38, 201326592
s_add_u32 s36, s36, s52
s_addc_u32 s37, s37, 0
s_sub_u32 s38, s38, s52
s_and_b32 s37, s37, 0xffff
s_mov_b32 s39, 0x20000
s_lshl_b32 s52, s73, 8
s_mov_b32 s40, s12
s_mov_b32 s41, s13
s_mov_b32 s42, 2097152
s_add_u32 s40, s40, s52
s_addc_u32 s41, s41, 0
s_sub_u32 s42, s42, s52
s_and_b32 s41, s41, 0xffff
s_mov_b32 s43, 0x20000
s_lshr_b32 s48, s34, 2
s_and_b32 s49, s34, 3
s_mul_i32 s50, s34, 2
s_lshr_b32 s51, s50, 2
s_and_b32 s50, s50, 3
s_mul_i32 s51, s51, 65536
s_lshl_b32 s50, s50, 10
s_add_u32 s50, s50, s51
v_lshlrev_b32 v20, 4, v0
v_add_u32 v2, s50, v20
v_mov_b32 v3, v2
s_lshl_b32 s50, s34, 3
s_add_u32 s50, s50, 0
v_lshrrev_b32 v20, 4, v0
v_add_u32 v20, s50, v20
v_and_b32 v21, 3, v20
v_lshlrev_b32 v21, 2, v21
v_bfe_u32 v22, v20, 2, 1
v_lshl_or_b32 v21, v22, 1, v21
v_and_b32 v22, 15, v0
v_xor_b32 v21, v21, v22
v_mul_u32_u24 v20, 2048, v20
v_lshl_add_u32 v20, v21, 4, v20
v_subrev_u32 v4, 0, v20
s_lshl_b32 s50, s34, 3
s_add_u32 s50, s50, 4
v_lshrrev_b32 v20, 4, v0
v_add_u32 v20, s50, v20
v_and_b32 v21, 3, v20
v_lshlrev_b32 v21, 2, v21
v_bfe_u32 v22, v20, 2, 1
v_lshl_or_b32 v21, v22, 1, v21
v_and_b32 v22, 15, v0
v_xor_b32 v21, v21, v22
v_mul_u32_u24 v20, 2048, v20
v_lshl_add_u32 v20, v21, 4, v20
v_subrev_u32 v5, 1024, v20
s_mul_i32 s67, s34, 2048
s_mul_i32 s68, s34, 2048
s_add_u32 s68, s68, 81920
s_mul_i32 s65, s35, 1
s_and_b32 s65, s65, 15
s_mul_i32 s64, s65, 4096
s_mul_i32 s65, s65, 131072
s_mov_b32 s69, 0
Lpro_116:
s_add_u32 s69, s69, 1
s_cmp_eq_u32 s69, 5
s_cselect_b32 s69, 0, s69
s_mov_b32 s62, 16384
s_cselect_b32 s62, 0xffff0000, s62
s_mov_b32 s63, 16384
s_cselect_b32 s63, 0xffff0000, s63
s_mov_b32 m0, s67
s_nop 0
buffer_load_dwordx4 v2, s[36:39], s64 offen offset:0 sc1 lds
buffer_load_dwordx4 v3, s[36:39], s64 offen offset:1024 sc1 lds
s_add_u32 s64, s64, 4096
s_add_u32 s67, s67, s62
s_bitset0_b32 s64, 16
s_cmp_eq_u32 s69, 0
s_cbranch_scc1 Lprox_117
s_mov_b32 m0, s68
s_nop 0
buffer_load_dwordx4 v4, s[40:43], s65 offen offset:0 lds
buffer_load_dwordx4 v5, s[40:43], s65 offen offset:1024 lds
s_add_u32 s65, s65, 131072
s_add_u32 s68, s68, s63
s_bitset0_b32 s65, 21
s_branch Lpro_116
Lprox_117:
s_lshr_b32 s48, s34, 2
s_and_b32 s49, s34, 3
s_mul_i32 s50, s48, 8192
v_and_b32 v20, 15, v0
v_lshlrev_b32 v20, 4, v20
v_lshrrev_b32 v21, 4, v0
v_lshl_add_u32 v20, v21, 9, v20
v_add_u32 v6, s50, v20
v_bfe_u32 v20, v0, 2, 2
v_lshrrev_b32 v21, 5, v0
v_lshl_add_u32 v21, v21, 4, v20
v_bfe_u32 v22, v0, 4, 1
v_lshl_add_u32 v21, v22, 2, v21
v_mul_u32_u24 v21, 256, v21
v_and_b32 v22, 3, v0
v_lshl_add_u32 v21, v22, 3, v21
v_add_u32 v21, 81920, v21
v_bfe_u32 v22, v0, 4, 1
v_lshl_or_b32 v20, v20, 1, v22
s_mul_i32 s50, s49, 2
s_add_u32 s51, s50, 0
v_xor_b32 v22, s51, v20
v_lshl_add_u32 v7, v22, 5, v21
s_add_u32 s51, s50, 1
v_xor_b32 v22, s51, v20
v_lshl_add_u32 v8, v22, 5, v21
v_mov_b64 v[128:129], 0
v_mov_b64 v[130:131], 0
v_mov_b64 v[132:133], 0
v_mov_b64 v[134:135], 0
v_mov_b64 v[136:137], 0
v_mov_b64 v[138:139], 0
v_mov_b64 v[140:141], 0
v_mov_b64 v[142:143], 0
v_mov_b64 v[144:145], 0
v_mov_b64 v[146:147], 0
v_mov_b64 v[148:149], 0
v_mov_b64 v[150:151], 0
v_mov_b64 v[152:153], 0
v_mov_b64 v[154:155], 0
v_mov_b64 v[156:157], 0
v_mov_b64 v[158:159], 0
s_mov_b32 s77, 0
s_waitcnt vmcnt(14)
s_barrier
ds_read_b64_tr_b16 v[56:57], v7 offset:0
ds_read_b64_tr_b16 v[58:59], v7 offset:2048
ds_read_b128 v[24:27], v6 offset:0
ds_read_b128 v[28:31], v6 offset:256
ds_read_b128 v[32:35], v6 offset:4096
ds_read_b128 v[36:39], v6 offset:4352
ds_read_b64_tr_b16 v[60:61], v8 offset:0
ds_read_b64_tr_b16 v[62:63], v8 offset:2048
s_mov_b32 s66, 0
s_branch Lgn_123
.p2align 6
Lg_118:
s_waitcnt vmcnt(12) lgkmcnt(0)
s_barrier
Lgb_119:
v_mfma_f32_16x16x32_bf16 v[128:131], v[64:67], v[40:43], v[128:131]
ds_read_b64_tr_b16 v[56:57], v7 offset:0
ds_read_b64_tr_b16 v[58:59], v7 offset:2048
v_mfma_f32_16x16x32_bf16 v[132:135], v[64:67], v[44:47], v[132:135]
ds_read_b128 v[24:27], v6 offset:0
ds_read_b128 v[28:31], v6 offset:256
v_mfma_f32_16x16x32_bf16 v[136:139], v[64:67], v[48:51], v[136:139]
s_mov_b32 m0, s67
s_nop 0
buffer_load_dwordx4 v2, s[36:39], s64 offen offset:0 sc1 lds
ds_read_b128 v[32:35], v6 offset:4096
v_mfma_f32_16x16x32_bf16 v[140:143], v[64:67], v[52:55], v[140:143]
ds_read_b128 v[36:39], v6 offset:4352
ds_read_b64_tr_b16 v[60:61], v8 offset:0
v_mfma_f32_16x16x32_bf16 v[144:147], v[68:71], v[40:43], v[144:147]
ds_read_b64_tr_b16 v[62:63], v8 offset:2048
buffer_load_dwordx4 v3, s[36:39], s64 offen offset:1024 sc1 lds
s_add_u32 s64, s64, 4096
s_add_u32 s67, s67, s62
s_bitset0_b32 s64, 16
v_mfma_f32_16x16x32_bf16 v[148:151], v[68:71], v[44:47], v[148:151]
s_add_u32 s66, s66, 1
s_cmp_eq_u32 s66, 16
v_mfma_f32_16x16x32_bf16 v[152:155], v[68:71], v[48:51], v[152:155]
v_mfma_f32_16x16x32_bf16 v[156:159], v[68:71], v[52:55], v[156:159]
s_cbranch_scc1 Lge_125
Lgn_123:
s_waitcnt lgkmcnt(0)
v_mfma_f32_16x16x32_bf16 v[128:131], v[56:59], v[24:27], v[128:131]
ds_read_b64_tr_b16 v[64:65], v7 offset:8192
ds_read_b64_tr_b16 v[66:67], v7 offset:10240
v_mfma_f32_16x16x32_bf16 v[132:135], v[56:59], v[28:31], v[132:135]
ds_read_b128 v[40:43], v6 offset:2048
ds_read_b128 v[44:47], v6 offset:2304
v_mfma_f32_16x16x32_bf16 v[136:139], v[56:59], v[32:35], v[136:139]
s_mov_b32 m0, s68
s_nop 0
buffer_load_dwordx4 v4, s[40:43], s65 offen offset:0 lds
ds_read_b128 v[48:51], v6 offset:6144
v_mfma_f32_16x16x32_bf16 v[140:143], v[56:59], v[36:39], v[140:143]
ds_read_b128 v[52:55], v6 offset:6400
ds_read_b64_tr_b16 v[68:69], v8 offset:8192
v_mfma_f32_16x16x32_bf16 v[144:147], v[60:63], v[24:27], v[144:147]
ds_read_b64_tr_b16 v[70:71], v8 offset:10240
buffer_load_dwordx4 v5, s[40:43], s65 offen offset:1024 lds
s_add_u32 s65, s65, 131072
s_add_u32 s68, s68, s63
s_bitset0_b32 s65, 21
v_mfma_f32_16x16x32_bf16 v[148:151], v[60:63], v[28:31], v[148:151]
s_add_u32 s69, s69, 1
s_cmp_eq_u32 s69, 5
s_cselect_b32 s69, 0, s69
s_mov_b32 s62, 16384
s_cselect_b32 s62, 0xffff0000, s62
s_mov_b32 s63, 16384
s_cselect_b32 s63, 0xffff0000, s63
v_add_u32 v6, s62, v6
v_mfma_f32_16x16x32_bf16 v[152:155], v[60:63], v[32:35], v[152:155]
v_add_u32 v7, s63, v7
v_add_u32 v8, s63, v8
v_mfma_f32_16x16x32_bf16 v[156:159], v[60:63], v[36:39], v[156:159]
s_cmp_eq_u32 s66, 11
s_cbranch_scc1 Lgs_121
Lgsb_122:
s_cmp_eq_u32 s77, 0
s_cbranch_scc1 Lg_118
s_branch Lgh_120
Lge_125:
s_mov_b32 s66, 0
s_branch Lgx_124
Lgs_121:
s_mov_b32 s38, 0
s_mov_b32 s42, 0
s_branch Lgsb_122
Lgh_120:
s_sub_u32 s77, s77, 1
s_cmp_eq_u32 s77, 0
s_cbranch_scc1 Lgst_126
s_waitcnt vmcnt(12) lgkmcnt(0)
s_barrier
s_branch Lgb_119
Lgst_126:
s_waitcnt vmcnt(2) lgkmcnt(0)
s_barrier
s_branch Lgb_119
Lgx_124:
s_waitcnt vmcnt(0) lgkmcnt(0)
s_lshl_b32 s58, s73, 8
s_lshl_b32 s59, s72, 19
s_add_u32 s58, s58, s59
s_mov_b32 s44, s28
s_mov_b32 s45, s29
s_mov_b32 s46, 8388608
s_add_u32 s44, s44, s58
s_addc_u32 s45, s45, 0
s_sub_u32 s46, s46, s58
s_and_b32 s45, s45, 0xffff
s_mov_b32 s47, 0x20000
s_lshr_b32 s60, s34, 2
s_and_b32 s61, s34, 3
s_mul_i32 s58, s60, 262144
s_mul_i32 s59, s61, 64
s_add_u32 s58, s58, s59
v_and_b32 v92, 15, v0
v_lshlrev_b32 v92, 12, v92
v_lshrrev_b32 v93, 5, v0
v_lshl_add_u32 v92, v93, 4, v92
v_bfe_u32 v93, v0, 4, 1
v_lshl_add_u32 v92, v93, 5, v92
v_cvt_pk_bf16_f32 v96, v128, v129
v_cvt_pk_bf16_f32 v97, v130, v131
v_cvt_pk_bf16_f32 v98, v144, v145
v_cvt_pk_bf16_f32 v99, v146, v147
s_nop 0
v_permlane16_swap_b32 v96, v98
v_permlane16_swap_b32 v97, v99
buffer_store_dwordx4 v[96:99], v92, s[44:47], s58 offen offset:0
v_cvt_pk_bf16_f32 v100, v132, v133
v_cvt_pk_bf16_f32 v101, v134, v135
v_cvt_pk_bf16_f32 v102, v148, v149
v_cvt_pk_bf16_f32 v103, v150, v151
s_nop 0
v_permlane16_swap_b32 v100, v102
v_permlane16_swap_b32 v101, v103
s_add_u32 s58, s58, 65536
buffer_store_dwordx4 v[100:103], v92, s[44:47], s58 offen offset:0
v_cvt_pk_bf16_f32 v104, v136, v137
v_cvt_pk_bf16_f32 v105, v138, v139
v_cvt_pk_bf16_f32 v106, v152, v153
v_cvt_pk_bf16_f32 v107, v154, v155
s_nop 0
v_permlane16_swap_b32 v104, v106
v_permlane16_swap_b32 v105, v107
s_add_u32 s58, s58, 65536
buffer_store_dwordx4 v[104:107], v92, s[44:47], s58 offen offset:0
v_cvt_pk_bf16_f32 v108, v140, v141
v_cvt_pk_bf16_f32 v109, v142, v143
v_cvt_pk_bf16_f32 v110, v156, v157
v_cvt_pk_bf16_f32 v111, v158, v159
s_nop 0
v_permlane16_swap_b32 v108, v110
v_permlane16_swap_b32 v109, v111
s_add_u32 s58, s58, 65536
buffer_store_dwordx4 v[108:111], v92, s[44:47], s58 offen offset:0
s_barrier
s_branch Lnext
Ljob0:
v_lshlrev_b32 v2, 4, v0
v_and_b32 v3, 15, v0
v_lshlrev_b32 v3, 12, v3
v_bfe_u32 v4, v0, 4, 1
v_lshl_add_u32 v3, v4, 5, v3
v_lshrrev_b32 v4, 5, v0
v_lshl_add_u32 v3, v4, 4, v3
s_mov_b32 s54, 0xffff0000
s_mov_b32 s75, s73
s_cmp_eq_u32 s75, 2
s_cbranch_scc1 Lrlast
s_cmp_gt_u32 s34, 5
s_cbranch_scc1 Lrmid
s_lshl_b32 s72, s34, 7
s_add_u32 s72, s72, s70
s_mov_b32 s73, 0
s_mov_b32 s74, 4
Lrunit:
s_lshr_b32 s76, s72, 4
s_lshl_b32 s53, s76, 17
s_add_u32 s76, s76, 4
s_min_u32 s76, s76, 63
v_mov_b32 v4, 0
Lpoll_127:
global_load_dword v5, v4, s[30:31] offset:64 sc1
s_add_u32 s79, s79, 1
s_cmp_gt_u32 s79, 400000
s_cbranch_scc1 Lwfail
s_waitcnt vmcnt(0)
v_readfirstlane_b32 s48, v5
s_nop 0
s_cmp_ge_u32 s48, s76
s_cbranch_scc1 Lok_128
s_sleep 20
s_branch Lpoll_127
Lok_128:
s_and_b32 s52, s72, 15
s_lshl_b32 s52, s52, 7
s_add_u32 s53, s53, s52
s_lshl_b32 s52, s72, 15
s_add_u32 s36, s32, 100663296
s_addc_u32 s37, s33, 0
s_mov_b32 s38, 167772160
s_add_u32 s36, s36, s52
s_addc_u32 s37, s37, 0
s_sub_u32 s38, s38, s52
s_and_b32 s37, s37, 0xffff
s_mov_b32 s39, 0x20000
s_add_u32 s44, s28, 2048
s_addc_u32 s45, s29, 0
s_mov_b32 s46, 8386560
s_add_u32 s44, s44, s53
s_addc_u32 s45, s45, 0
s_sub_u32 s46, s46, s53
s_and_b32 s45, s45, 0xffff
s_mov_b32 s47, 0x20000
Lrpiece:
s_lshl_b32 s55, s73, 10
buffer_load_dwordx4 v[16:19], v2, s[36:39], s55 offen sc1
s_add_u32 s55, s55, 4096
buffer_load_dwordx4 v[20:23], v2, s[36:39], s55 offen sc1
s_add_u32 s55, s55, 4096
buffer_load_dwordx4 v[24:27], v2, s[36:39], s55 offen sc1
s_add_u32 s55, s55, 4096
buffer_load_dwordx4 v[28:31], v2, s[36:39], s55 offen sc1
s_add_u32 s55, s55, 4096
buffer_load_dwordx4 v[32:35], v2, s[36:39], s55 offen sc1
s_add_u32 s55, s55, 4096
buffer_load_dwordx4 v[36:39], v2, s[36:39], s55 offen sc1
s_add_u32 s55, s55, 4096
buffer_load_dwordx4 v[40:43], v2, s[36:39], s55 offen sc1
s_add_u32 s55, s55, 4096
buffer_load_dwordx4 v[44:47], v2, s[36:39], s55 offen sc1
s_add_u32 s55, s55, 4096
s_add_u32 s79, s79, 1
s_cmp_gt_u32 s79, 400000
s_cbranch_scc1 Lwfail
s_lshr_b32 s55, s73, 1
s_lshl_b32 s55, s55, 16
s_and_b32 s56, s73, 1
s_lshl_b32 s56, s56, 6
s_add_u32 s55, s55, s56
s_waitcnt vmcnt(0)
v_max3_u32 v4, v19, v23, v27
v_max3_u32 v5, v31, v35, v39
v_max3_u32 v4, v43, v47, v4
v_max_u32 v4, v4, v5
v_cmp_eq_u32 vcc, -1, v4
s_cbranch_vccnz Lrpiece
v_lshlrev_b32 v48, 16, v16
v_and_b32 v49, s54, v16
v_lshlrev_b32 v50, 16, v17
v_and_b32 v51, s54, v17
v_lshlrev_b32 v52, 16, v18
v_and_b32 v53, s54, v18
v_lshlrev_b32 v54, 16, v19
v_and_b32 v55, s54, v19
v_lshlrev_b32 v8, 16, v20
v_and_b32 v9, s54, v20
v_pk_add_f32 v[48:49], v[48:49], v[8:9]
v_lshlrev_b32 v10, 16, v21
v_and_b32 v11, s54, v21
v_pk_add_f32 v[50:51], v[50:51], v[10:11]
v_lshlrev_b32 v12, 16, v22
v_and_b32 v13, s54, v22
v_pk_add_f32 v[52:53], v[52:53], v[12:13]
v_lshlrev_b32 v14, 16, v23
v_and_b32 v15, s54, v23
v_pk_add_f32 v[54:55], v[54:55], v[14:15]
v_lshlrev_b32 v8, 16, v24
v_and_b32 v9, s54, v24
v_pk_add_f32 v[48:49], v[48:49], v[8:9]
v_lshlrev_b32 v10, 16, v25
v_and_b32 v11, s54, v25
v_pk_add_f32 v[50:51], v[50:51], v[10:11]
v_lshlrev_b32 v12, 16, v26
v_and_b32 v13, s54, v26
v_pk_add_f32 v[52:53], v[52:53], v[12:13]
v_lshlrev_b32 v14, 16, v27
v_and_b32 v15, s54, v27
v_pk_add_f32 v[54:55], v[54:55], v[14:15]
v_lshlrev_b32 v8, 16, v28
v_and_b32 v9, s54, v28
v_pk_add_f32 v[48:49], v[48:49], v[8:9]
v_lshlrev_b32 v10, 16, v29
v_and_b32 v11, s54, v29
v_pk_add_f32 v[50:51], v[50:51], v[10:11]
v_lshlrev_b32 v12, 16, v30
v_and_b32 v13, s54, v30
v_pk_add_f32 v[52:53], v[52:53], v[12:13]
v_lshlrev_b32 v14, 16, v31
v_and_b32 v15, s54, v31
v_pk_add_f32 v[54:55], v[54:55], v[14:15]
v_lshlrev_b32 v8, 16, v32
v_and_b32 v9, s54, v32
v_pk_add_f32 v[48:49], v[48:49], v[8:9]
v_lshlrev_b32 v10, 16, v33
v_and_b32 v11, s54, v33
v_pk_add_f32 v[50:51], v[50:51], v[10:11]
v_lshlrev_b32 v12, 16, v34
v_and_b32 v13, s54, v34
v_pk_add_f32 v[52:53], v[52:53], v[12:13]
v_lshlrev_b32 v14, 16, v35
v_and_b32 v15, s54, v35
v_pk_add_f32 v[54:55], v[54:55], v[14:15]
v_lshlrev_b32 v8, 16, v36
v_and_b32 v9, s54, v36
v_pk_add_f32 v[48:49], v[48:49], v[8:9]
v_lshlrev_b32 v10, 16, v37
v_and_b32 v11, s54, v37
v_pk_add_f32 v[50:51], v[50:51], v[10:11]
v_lshlrev_b32 v12, 16, v38
v_and_b32 v13, s54, v38
v_pk_add_f32 v[52:53], v[52:53], v[12:13]
v_lshlrev_b32 v14, 16, v39
v_and_b32 v15, s54, v39
v_pk_add_f32 v[54:55], v[54:55], v[14:15]
v_lshlrev_b32 v8, 16, v40
v_and_b32 v9, s54, v40
v_pk_add_f32 v[48:49], v[48:49], v[8:9]
v_lshlrev_b32 v10, 16, v41
v_and_b32 v11, s54, v41
v_pk_add_f32 v[50:51], v[50:51], v[10:11]
v_lshlrev_b32 v12, 16, v42
v_and_b32 v13, s54, v42
v_pk_add_f32 v[52:53], v[52:53], v[12:13]
v_lshlrev_b32 v14, 16, v43
v_and_b32 v15, s54, v43
v_pk_add_f32 v[54:55], v[54:55], v[14:15]
v_lshlrev_b32 v8, 16, v44
v_and_b32 v9, s54, v44
v_pk_add_f32 v[48:49], v[48:49], v[8:9]
v_lshlrev_b32 v10, 16, v45
v_and_b32 v11, s54, v45
v_pk_add_f32 v[50:51], v[50:51], v[10:11]
v_lshlrev_b32 v12, 16, v46
v_and_b32 v13, s54, v46
v_pk_add_f32 v[52:53], v[52:53], v[12:13]
v_lshlrev_b32 v14, 16, v47
v_and_b32 v15, s54, v47
v_pk_add_f32 v[54:55], v[54:55], v[14:15]
v_cvt_pk_bf16_f32 v56, v48, v49
v_cvt_pk_bf16_f32 v57, v50, v51
v_cvt_pk_bf16_f32 v58, v52, v53
v_cvt_pk_bf16_f32 v59, v54, v55
buffer_store_dwordx4 v[56:59], v3, s[44:47], s55 offen
s_add_u32 s73, s73, 1
s_cmp_lt_u32 s73, s74
s_cbranch_scc1 Lrpiece
s_cmp_ge_u32 s72, 768
s_cbranch_scc1 Lrdone
Lrmid:
s_cmp_eq_u32 s75, 1
s_cbranch_scc1 Lnext
Lrlast:
s_lshr_b32 s72, s34, 2
s_lshl_b32 s72, s72, 7
s_sub_u32 s72, 896, s72
s_add_u32 s72, s72, s70
s_and_b32 s73, s34, 3
s_add_u32 s74, s73, 1
s_branch Lrunit
Lrdone:
Lend:
s_endpgm
Lwfail:
v_mov_b32 v2, 0
v_mov_b32 v3, 2
global_store_dword v2, v3, s[30:31] offset:76
s_endpgm
.p2align 6
Ltab:
.long 131328, 131840, 132112, 132608, 132872, 327936, 1, 328192, 2, 0, 0, 0, 0, 0, 0, 0
.long 131330, 131842, 132114, 132610, 132874, 327937, 1, 328193, 2, 0, 0, 0, 0, 0, 0, 0
.long 131332, 131844, 132116, 132612, 132876, 327938, 1, 328194, 2, 0, 0, 0, 0, 0, 0, 0
.long 131334, 131846, 132118, 132614, 132878, 327939, 1, 328195, 2, 0, 0, 0, 0, 0, 0, 0
.long 131336, 131848, 132352, 132616, 132880, 327940, 1, 328196, 2, 0, 0, 0, 0, 0, 0, 0
.long 131338, 131850, 132354, 132618, 132882, 327941, 1, 328197, 2, 0, 0, 0, 0, 0, 0, 0
.long 131340, 131852, 132356, 132620, 132884, 327942, 1, 328198, 2, 0, 0, 0, 0, 0, 0, 0
.long 131342, 131854, 132358, 132622, 132886, 327943, 1, 328199, 2, 0, 0, 0, 0, 0, 0, 0
.long 393216, 393472, 458752, 131584, 132096, 132360, 132624, 327680, 1, 328448, 2, 0, 0, 0, 0, 0
.long 393217, 393473, 459008, 131586, 132098, 132362, 132626, 327681, 1, 328449, 2, 0, 0, 0, 0, 0
.long 393218, 393474, 459264, 131588, 132100, 132364, 132628, 327682, 1, 328450, 2, 0, 0, 0, 0, 0
.long 393219, 393475, 459520, 131590, 132102, 132366, 132630, 327683, 1, 328451, 2, 0, 0, 0, 0, 0
.long 393220, 393476, 459776, 131592, 132104, 132368, 132864, 327684, 1, 328452, 2, 0, 0, 0, 0, 0
.long 393221, 393477, 460032, 131594, 132106, 132370, 132866, 327685, 1, 328453, 2, 0, 0, 0, 0, 0
.long 393222, 393478, 460288, 131596, 132108, 132372, 132868, 327686, 1, 328454, 2, 0, 0, 0, 0, 0
.long 393223, 393479, 460544, 131598, 132110, 132374, 132870, 327687, 1, 328455, 2, 0, 0, 0, 0, 0
.long 393224, 393480, 393744, 196608, 198656, 262144, 262656, 0, 0, 0, 0, 0, 0, 0, 0, 0
.long 393225, 393481, 394000, 196864, 198912, 262145, 262657, 0, 0, 0, 0, 0, 0, 0, 0, 0
.long 393226, 393482, 393745, 197120, 199168, 262146, 262658, 0, 0, 0, 0, 0, 0, 0, 0, 0
.long 393227, 393483, 394001, 197376, 199424, 262147, 262659, 0, 0, 0, 0, 0, 0, 0, 0, 0
.long 393228, 393484, 393746, 197632, 199680, 262148, 262660, 0, 0, 0, 0, 0, 0, 0, 0, 0
.long 393229, 393485, 394002, 197888, 199936, 262149, 262661, 0, 0, 0, 0, 0, 0, 0, 0, 0
.long 393230, 393486, 393747, 198144, 200192, 262150, 262662, 0, 0, 0, 0, 0, 0, 0, 0, 0
.long 393231, 393487, 394003, 198400, 200448, 262151, 262663, 0, 0, 0, 0, 0, 0, 0, 0, 0
.long 393232, 393488, 393748, 460800, 66064, 66320, 262400, 262912, 0, 0, 0, 0, 0, 0, 0, 0
.long 393233, 393489, 394004, 461056, 66065, 66321, 262401, 262913, 0, 0, 0, 0, 0, 0, 0, 0
.long 393234, 393490, 393749, 461312, 66066, 66322, 262402, 262914, 0, 0, 0, 0, 0, 0, 0, 0
.long 393235, 393491, 394005, 461568, 66067, 66323, 262403, 262915, 0, 0, 0, 0, 0, 0, 0, 0
.long 393236, 393492, 393750, 461824, 66068, 66324, 262404, 262916, 0, 0, 0, 0, 0, 0, 0, 0
.long 393237, 393493, 394006, 462080, 66069, 66325, 262405, 262917, 0, 0, 0, 0, 0, 0, 0, 0
.long 393238, 393494, 393751, 462336, 66070, 66326, 262406, 262918, 0, 0, 0, 0, 0, 0, 0, 0
.long 393239, 393495, 394007, 462592, 66071, 66327, 262407, 262919, 0, 0, 0, 0, 0, 0, 0, 0
.long 131352, 131864, 132136, 132632, 132896, 328960, 1, 329216, 2, 0, 0, 0, 0, 0, 0, 0
.long 131354, 131866, 132138, 132634, 132898, 328961, 1, 329217, 2, 0, 0, 0, 0, 0, 0, 0
.long 131356, 131868, 132140, 132636, 132900, 328962, 1, 329218, 2, 0, 0, 0, 0, 0, 0, 0
.long 131358, 131870, 132142, 132638, 132902, 328963, 1, 329219, 2, 0, 0, 0, 0, 0, 0, 0
.long 131360, 131872, 132376, 132640, 132904, 328964, 1, 329220, 2, 0, 0, 0, 0, 0, 0, 0
.long 131362, 131874, 132378, 132642, 132906, 328965, 1, 329221, 2, 0, 0, 0, 0, 0, 0, 0
.long 131364, 131876, 132380, 132644, 132908, 328966, 1, 329222, 2, 0, 0, 0, 0, 0, 0, 0
.long 131366, 131878, 132382, 132646, 132910, 328967, 1, 329223, 2, 0, 0, 0, 0, 0, 0, 0
.long 393240, 393496, 462848, 131608, 132120, 132384, 132648, 328704, 1, 329472, 2, 0, 0, 0, 0, 0
.long 393241, 393497, 463104, 131610, 132122, 132386, 132650, 328705, 1, 329473, 2, 0, 0, 0, 0, 0
.long 393242, 393498, 463360, 131612, 132124, 132388, 132652, 328706, 1, 329474, 2, 0, 0, 0, 0, 0
.long 393243, 393499, 463616, 131614, 132126, 132390, 132654, 328707, 1, 329475, 2, 0, 0, 0, 0, 0
.long 393244, 393500, 463872, 131616, 132128, 132392, 132888, 328708, 1, 329476, 2, 0, 0, 0, 0, 0
.long 393245, 393501, 464128, 131618, 132130, 132394, 132890, 328709, 1, 329477, 2, 0, 0, 0, 0, 0
.long 393246, 393502, 464384, 131620, 132132, 132396, 132892, 328710, 1, 329478, 2, 0, 0, 0, 0, 0
.long 393247, 393503, 464640, 131622, 132134, 132398, 132894, 328711, 1, 329479, 2, 0, 0, 0, 0, 0
.long 393248, 393504, 393768, 200704, 202752, 263168, 263680, 0, 0, 0, 0, 0, 0, 0, 0, 0
.long 393249, 393505, 394024, 200960, 203008, 263169, 263681, 0, 0, 0, 0, 0, 0, 0, 0, 0
.long 393250, 393506, 393769, 201216, 203264, 263170, 263682, 0, 0, 0, 0, 0, 0, 0, 0, 0
.long 393251, 393507, 394025, 201472, 203520, 263171, 263683, 0, 0, 0, 0, 0, 0, 0, 0, 0
.long 393252, 393508, 393770, 201728, 203776, 263172, 263684, 0, 0, 0, 0, 0, 0, 0, 0, 0
.long 393253, 393509, 394026, 201984, 204032, 263173, 263685, 0, 0, 0, 0, 0, 0, 0, 0, 0
.long 393254, 393510, 393771, 202240, 204288, 263174, 263686, 0, 0, 0, 0, 0, 0, 0, 0, 0
.long 393255, 393511, 394027, 202496, 204544, 263175, 263687, 0, 0, 0, 0, 0, 0, 0, 0, 0
.long 393256, 393512, 393772, 464896, 66088, 66344, 263424, 263936, 0, 0, 0, 0, 0, 0, 0, 0
.long 393257, 393513, 394028, 465152, 66089, 66345, 263425, 263937, 0, 0, 0, 0, 0, 0, 0, 0
.long 393258, 393514, 393773, 465408, 66090, 66346, 263426, 263938, 0, 0, 0, 0, 0, 0, 0, 0
.long 393259, 393515, 394029, 465664, 66091, 66347, 263427, 263939, 0, 0, 0, 0, 0, 0, 0, 0
.long 393260, 393516, 393774, 465920, 66092, 66348, 263428, 263940, 0, 0, 0, 0, 0, 0, 0, 0
.long 393261, 393517, 394030, 466176, 66093, 66349, 263429, 263941, 0, 0, 0, 0, 0, 0, 0, 0
.long 393262, 393518, 393775, 466432, 66094, 66350, 263430, 263942, 0, 0, 0, 0, 0, 0, 0, 0
.long 393263, 393519, 394031, 466688, 66095, 66351, 263431, 263943, 0, 0, 0, 0, 0, 0, 0, 0
.long 131376, 131888, 132160, 132656, 132920, 329984, 1, 330240, 2, 0, 0, 0, 0, 0, 0, 0
.long 131378, 131890, 132162, 132658, 132922, 329985, 1, 330241, 2, 0, 0, 0, 0, 0, 0, 0
.long 131380, 131892, 132164, 132660, 132924, 329986, 1, 330242, 2, 0, 0, 0, 0, 0, 0, 0
.long 131382, 131894, 132166, 132662, 132926, 329987, 1, 330243, 2, 0, 0, 0, 0, 0, 0, 0
.long 131384, 131896, 132400, 132664, 132928, 329988, 1, 330244, 2, 0, 0, 0, 0, 0, 0, 0
.long 131386, 131898, 132402, 132666, 132930, 329989, 1, 330245, 2, 0, 0, 0, 0, 0, 0, 0
.long 131388, 131900, 132404, 132668, 132932, 329990, 1, 330246, 2, 0, 0, 0, 0, 0, 0, 0
.long 131390, 131902, 132406, 132670, 132934, 329991, 1, 330247, 2, 0, 0, 0, 0, 0, 0, 0
.long 393264, 393520, 466944, 131632, 132144, 132408, 132672, 329728, 1, 330496, 2, 0, 0, 0, 0, 0
.long 393265, 393521, 467200, 131634, 132146, 132410, 132674, 329729, 1, 330497, 2, 0, 0, 0, 0, 0
.long 393266, 393522, 467456, 131636, 132148, 132412, 132676, 329730, 1, 330498, 2, 0, 0, 0, 0, 0
.long 393267, 393523, 467712, 131638, 132150, 132414, 132678, 329731, 1, 330499, 2, 0, 0, 0, 0, 0
.long 393268, 393524, 467968, 131640, 132152, 132416, 132912, 329732, 1, 330500, 2, 0, 0, 0, 0, 0
.long 393269, 393525, 468224, 131642, 132154, 132418, 132914, 329733, 1, 330501, 2, 0, 0, 0, 0, 0
.long 393270, 393526, 468480, 131644, 132156, 132420, 132916, 329734, 1, 330502, 2, 0, 0, 0, 0, 0
.long 393271, 393527, 468736, 131646, 132158, 132422, 132918, 329735, 1, 330503, 2, 0, 0, 0, 0, 0
.long 393272, 393528, 393792, 204800, 206848, 264192, 264704, 0, 0, 0, 0, 0, 0, 0, 0, 0
.long 393273, 393529, 394048, 205056, 207104, 264193, 264705, 0, 0, 0, 0, 0, 0, 0, 0, 0
.long 393274, 393530, 393793, 205312, 207360, 264194, 264706, 0, 0, 0, 0, 0, 0, 0, 0, 0
.long 393275, 393531, 394049, 205568, 207616, 264195, 264707, 0, 0, 0, 0, 0, 0, 0, 0, 0
.long 393276, 393532, 393794, 205824, 207872, 264196, 264708, 0, 0, 0, 0, 0, 0, 0, 0, 0
.long 393277, 393533, 394050, 206080, 208128, 264197, 264709, 0, 0, 0, 0, 0, 0, 0, 0, 0
.long 393278, 393534, 393795, 206336, 208384, 264198, 264710, 0, 0, 0, 0, 0, 0, 0, 0, 0
.long 393279, 393535, 394051, 206592, 208640, 264199, 264711, 0, 0, 0, 0, 0, 0, 0, 0, 0
.long 393280, 393536, 393796, 468992, 66112, 66368, 264448, 264960, 0, 0, 0, 0, 0, 0, 0, 0
.long 393281, 393537, 394052, 469248, 66113, 66369, 264449, 264961, 0, 0, 0, 0, 0, 0, 0, 0
.long 393282, 393538, 393797, 469504, 66114, 66370, 264450, 264962, 0, 0, 0, 0, 0, 0, 0, 0
.long 393283, 393539, 394053, 469760, 66115, 66371, 264451, 264963, 0, 0, 0, 0, 0, 0, 0, 0
.long 393284, 393540, 393798, 470016, 66116, 66372, 264452, 264964, 0, 0, 0, 0, 0, 0, 0, 0
.long 393285, 393541, 394054, 470272, 66117, 66373, 264453, 264965, 0, 0, 0, 0, 0, 0, 0, 0
.long 393286, 393542, 393799, 470528, 66118, 66374, 264454, 264966, 0, 0, 0, 0, 0, 0, 0, 0
.long 393287, 393543, 394055, 470784, 66119, 66375, 264455, 264967, 0, 0, 0, 0, 0, 0, 0, 0
.long 131400, 131912, 132184, 132680, 132944, 331008, 1, 331264, 2, 0, 0, 0, 0, 0, 0, 0
.long 131402, 131914, 132186, 132682, 132946, 331009, 1, 331265, 2, 0, 0, 0, 0, 0, 0, 0
.long 131404, 131916, 132188, 132684, 132948, 331010, 1, 331266, 2, 0, 0, 0, 0, 0, 0, 0
.long 131406, 131918, 132190, 132686, 132950, 331011, 1, 331267, 2, 0, 0, 0, 0, 0, 0, 0
.long 131408, 131920, 132424, 132688, 132952, 331012, 1, 331268, 2, 0, 0, 0, 0, 0, 0, 0
.long 131410, 131922, 132426, 132690, 132954, 331013, 1, 331269, 2, 0, 0, 0, 0, 0, 0, 0
.long 131412, 131924, 132428, 132692, 132956, 331014, 1, 331270, 2, 0, 0, 0, 0, 0, 0, 0
.long 131414, 131926, 132430, 132694, 132958, 331015, 1, 331271, 2, 0, 0, 0, 0, 0, 0, 0
.long 393288, 393544, 471040, 131656, 132168, 132432, 132696, 330752, 1, 331520, 2, 0, 0, 0, 0, 0
.long 393289, 393545, 471296, 131658, 132170, 132434, 132698, 330753, 1, 331521, 2, 0, 0, 0, 0, 0
.long 393290, 393546, 471552, 131660, 132172, 132436, 132700, 330754, 1, 331522, 2, 0, 0, 0, 0, 0
.long 393291, 393547, 471808, 131662, 132174, 132438, 132702, 330755, 1, 331523, 2, 0, 0, 0, 0, 0
.long 393292, 393548, 472064, 131664, 132176, 132440, 132936, 330756, 1, 331524, 2, 0, 0, 0, 0, 0
.long 393293, 393549, 472320, 131666, 132178, 132442, 132938, 330757, 1, 331525, 2, 0, 0, 0, 0, 0
.long 393294, 393550, 472576, 131668, 132180, 132444, 132940, 330758, 1, 331526, 2, 0, 0, 0, 0, 0
.long 393295, 393551, 472832, 131670, 132182, 132446, 132942, 330759, 1, 331527, 2, 0, 0, 0, 0, 0
.long 393296, 393552, 393816, 208896, 210944, 265216, 265728, 0, 0, 0, 0, 0, 0, 0, 0, 0
.long 393297, 393553, 394072, 209152, 211200, 265217, 265729, 0, 0, 0, 0, 0, 0, 0, 0, 0
.long 393298, 393554, 393817, 209408, 211456, 265218, 265730, 0, 0, 0, 0, 0, 0, 0, 0, 0
.long 393299, 393555, 394073, 209664, 211712, 265219, 265731, 0, 0, 0, 0, 0, 0, 0, 0, 0
.long 393300, 393556, 393818, 209920, 211968, 265220, 265732, 0, 0, 0, 0, 0, 0, 0, 0, 0
.long 393301, 393557, 394074, 210176, 212224, 265221, 265733, 0, 0, 0, 0, 0, 0, 0, 0, 0
.long 393302, 393558, 393819, 210432, 212480, 265222, 265734, 0, 0, 0, 0, 0, 0, 0, 0, 0
.long 393303, 393559, 394075, 210688, 212736, 265223, 265735, 0, 0, 0, 0, 0, 0, 0, 0, 0
.long 393304, 393560, 393820, 473088, 66136, 66392, 265472, 265984, 0, 0, 0, 0, 0, 0, 0, 0
.long 393305, 393561, 394076, 473344, 66137, 66393, 265473, 265985, 0, 0, 0, 0, 0, 0, 0, 0
.long 393306, 393562, 393821, 473600, 66138, 66394, 265474, 265986, 0, 0, 0, 0, 0, 0, 0, 0
.long 393307, 393563, 394077, 473856, 66139, 66395, 265475, 265987, 0, 0, 0, 0, 0, 0, 0, 0
.long 393308, 393564, 393822, 474112, 66140, 66396, 265476, 265988, 0, 0, 0, 0, 0, 0, 0, 0
.long 393309, 393565, 394078, 474368, 66141, 66397, 265477, 265989, 0, 0, 0, 0, 0, 0, 0, 0
.long 393310, 393566, 393823, 474624, 66142, 66398, 265478, 265990, 0, 0, 0, 0, 0, 0, 0, 0
.long 393311, 393567, 394079, 474880, 66143, 66399, 265479, 265991, 0, 0, 0, 0, 0, 0, 0, 0
.section .rodata,"a"
.p2align 6
.amdhsa_kernel concat_heads__grouped_kv_mqa__memory_aug_recurrent_mem_tr__prompt_kernel
  .amdhsa_next_free_vgpr 256
  .amdhsa_next_free_sgpr 102
  .amdhsa_accum_offset 256
  .amdhsa_group_segment_fixed_size 0
  .amdhsa_kernarg_size 120
  .amdhsa_user_sgpr_count 2
  .amdhsa_user_sgpr_kernarg_segment_ptr 1
  .amdhsa_system_sgpr_workgroup_id_x 1
.end_amdhsa_kernel
```
